```python
import torch

def _softmax(x, axis=-1):
    return torch.softmax(x, dim=axis)
def _gelu(x):
    return torch.nn.functional.gelu(x, approximate="tanh")
def _silu(x):
    return torch.nn.functional.silu(x)
def _sigmoid(x):
    return torch.sigmoid(x)
def _layernorm(x, axis=-1, eps=1e-5):
    m = x.mean(dim=axis, keepdim=True)
    v = x.var(dim=axis, keepdim=True, unbiased=False)
    return (x - m) / torch.sqrt(v + eps)
def _scatter_add(tgt, idx, src, axis=0):
    return tgt.clone().index_add_(axis, idx, src)
def _segment_sum(src, seg, n):
    out = torch.zeros((n,) + src.shape[1:], dtype=src.dtype)
    return out.index_add_(0, seg, src)
def _pad(x, pw):
    flat = tuple(v for pair in reversed(pw) for v in pair)
    return torch.nn.functional.pad(x, flat)

kernel_name = 'sequential_preLN__sliding_block_cached__glu_gated_glu__decode'

def setup_inputs():

    _w = (lambda a: (lambda t: t.to(torch.bfloat16) if t.is_floating_point() else t)(torch.as_tensor(a)))
    def _A_setup():
        B, Sq, D = 4, 1, 512
        Hq, Hkv, Sk, Dh = 32, 8, 8192, 128
        assert Hq % Hkv == 0, (Hq, Hkv)
        return {
            "x": _w((lambda *s: torch.randn(*s, dtype=torch.bfloat16) * 0.05)(B, Sq, D)),
            "k_cache": _w((lambda *s: torch.randn(*s, dtype=torch.bfloat16) * 3.2)(B, Hkv, Sk, Dh)),
            "v_cache": _w((lambda *s: torch.randn(*s, dtype=torch.bfloat16) * 0.4)(B, Hkv, Sk, Dh)),
            "wq": _w((lambda *s: torch.randn(*s, dtype=torch.bfloat16) * 3.2)(D, Hq * Dh) * (D ** -0.5)),
            "wo": _w((lambda *s: torch.randn(*s, dtype=torch.bfloat16) * 0.4)(Hq * Dh, D) * ((Hq * Dh) ** -0.5)),
        }
    _A_in = _A_setup()

    def _B_setup():
        B, S, D, F = 4, 1, 512, 1792
        return {
            "x": _w((lambda *s: torch.randn(*s, dtype=torch.bfloat16) * 0.05)(B, S, D)),
            "w_gate": _w((lambda *s: torch.randn(*s, dtype=torch.bfloat16) * 0.1)(D, F)),
            "w_up": _w((lambda *s: torch.randn(*s, dtype=torch.bfloat16) * 0.05)(D, F)),
            "w_down": _w((lambda *s: torch.randn(*s, dtype=torch.bfloat16) * 0.05)(F, D)),
        }
    _B_in = _B_setup()

    return {
        "A_x": _A_in["x"],
        "A_k_cache": _A_in["k_cache"],
        "A_v_cache": _A_in["v_cache"],
        "A_wq": _A_in["wq"],
        "A_wo": _A_in["wo"],
        "B_x": _B_in["x"],
        "B_w_gate": _B_in["w_gate"],
        "B_w_up": _B_in["w_up"],
        "B_w_down": _B_in["w_down"],
    }

def reference(A_x, A_k_cache, A_v_cache, A_wq, A_wo, B_x, B_w_gate, B_w_up, B_w_down):
    def _A_ref(x, k_cache, v_cache, wq, wo):
        B, Sq, D = x.shape
        Hq, Dh = 32, 128
        Hkv, Sk = k_cache.shape[1], k_cache.shape[2]
        W = min(4096, max(256, Sk // 4))
        rep = Hq // Hkv
        q = (lambda x, *d: x.permute(*d))((x @ wq).reshape(B, Sq, Hq, Dh), 0, 2, 1, 3)
        k = (lambda x, n, axis: torch.repeat_interleave(x, n, dim=axis))(k_cache[:, :, Sk - W:, :], rep, axis=1)
        v = (lambda x, n, axis: torch.repeat_interleave(x, n, dim=axis))(v_cache[:, :, Sk - W:, :], rep, axis=1)
        scores = torch.einsum("bhqd,bhkd->bhqk", q, k) * (Dh ** -0.5)
        p = _softmax(scores, axis=-1)
        o = torch.einsum("bhqk,bhkd->bhqd", p, v)
        return (lambda x, *d: x.permute(*d))(o, 0, 2, 1, 3).reshape(B, Sq, Hq * Dh) @ wo

    def _B_ref(x, w_gate, w_up, w_down):
        g = torch.einsum("bsd,df->bsf", x, w_gate)
        u = torch.einsum("bsd,df->bsf", x, w_up)
        h = _sigmoid(g) * u
        return torch.einsum("bsf,fd->bsd", h, w_down)

    x = A_x
    h = x + _A_ref(_layernorm(x, axis=-1), A_k_cache, A_v_cache, A_wq, A_wo)
    h2 = h + _B_ref(_layernorm(h, axis=-1), B_w_gate, B_w_up, B_w_down)
    return h2
```

```asm
; @launch grid=(256,1,1) block=(1024,1,1) lds=139264
.amdgcn_target "amdgcn-amd-amdhsa--gfx950"
.text
.globl sequential_preLN__sliding_block_cached__glu_gated_glu__decode_kernel
.p2align 8
.type sequential_preLN__sliding_block_cached__glu_gated_glu__decode_kernel,@function
sequential_preLN__sliding_block_cached__glu_gated_glu__decode_kernel:
  s_cmp_ge_u32 s2, 256
  s_cbranch_scc1 L_exit
  s_load_dwordx16 s[32:47], s[0:1], 0
  s_load_dwordx8 s[48:55], s[0:1], 64
  v_lshrrev_b32 v1, 6, v0
  v_mov_b32 v3, 0
  v_readfirstlane_b32 s3, v1
  v_and_b32 v0, 63, v0
  s_and_b32 s4, s2, 7
  s_lshr_b32 s5, s2, 3
  s_getpc_b64 s[56:57]
L_pc:
  s_lshl_b32 s27, s5, 4
  s_add_u32 s27, s27, s3
  s_and_b32 s27, s27, 127
  s_lshl_b32 s27, s27, 7
  s_min_u32 s27, s27, L_code_end-L_pc-4
  v_mov_b32 v126, s27
  global_load_dword v127, v126, s[56:57]
  v_and_b32 v1, 15, v0
  v_lshrrev_b32 v2, 4, v0
  s_mul_i32 s6, s5, 43
  s_lshr_b32 s6, s6, 8
  s_mul_i32 s7, s6, 6
  s_sub_u32 s7, s5, s7
  s_mul_i32 s28, s7, 10
  s_cmp_eq_u32 s7, 5
  s_cselect_b32 s28, 52, s28
  s_cmp_ge_u32 s7, 4
  s_cselect_b32 s29, 12, 10
  s_cselect_b32 s27, 1, 0
  v_mov_b32 v4, 0
  v_mov_b32 v5, 0
  v_mov_b32 v6, s27
  v_mov_b32 v7, 0
  ds_write_b128 v3, v[4:7]
  v_mov_b32 v6, 0
  ds_write_b128 v3, v[4:7] offset:16
  ds_write_b64 v3, v[4:5] offset:32
  s_lshl_b32 s27, s6, 3
  s_add_u32 s27, s27, s4
  s_mul_i32 s63, s27, 10
  s_lshr_b32 s63, s63, 5
  s_lshl_b32 s27, s27, 8
  s_add_u32 s62, s28, s27
  s_add_u32 s62, s62, 192
  s_cmp_ge_u32 s3, 5
  s_cselect_b32 s27, 5, 1
  s_sub_u32 s27, s3, s27
  s_mov_b32 s59, 4
  s_add_u32 s63, s63, s27
  s_cmp_ge_u32 s63, s29
  s_cselect_b32 s28, s29, 0
  s_sub_u32 s63, s63, s28
  s_add_u32 s28, s62, s63
  s_lshl_b32 s28, s28, 13
  s_lshl_b32 s31, s27, 13
  s_add_u32 s31, s31, 40960
  s_mov_b32 s10, 0x10000000
  s_mov_b32 s11, 0x20000
  s_mov_b32 s14, 0x4000000
  s_mov_b32 s15, 0x20000
  v_xor_b32 v4, v1, v2
  v_lshlrev_b32 v4, 4, v4
  v_lshl_add_u32 v4, v2, 8, v4
  v_xor_b32 v5, 64, v4
  v_xor_b32 v6, 0x80, v4
  v_xor_b32 v7, 0xc0, v4
  v_lshlrev_b32 v8, 4, v1
  v_lshl_add_u32 v8, v2, 10, v8
  s_mov_b32 s22, s31
  s_mov_b32 s23, s28
  s_mov_b32 m0, s22
  s_waitcnt lgkmcnt(0)
  s_mov_b64 s[8:9], s[54:55]
  s_cmp_ge_u32 s5, 24
  s_cbranch_scc1 L_nonatt
  s_cmp_ge_u32 s3, 5
  s_cbranch_scc1 L_vwave
  s_cmp_eq_u32 s3, 0
  s_cbranch_scc1 L_w0
  s_mov_b64 s[12:13], s[34:35]
  s_add_u32 s22, s22, 4096
  buffer_load_dwordx4 v4, s[12:15], s23 offen offset:0 nt lds
  buffer_load_dwordx4 v5, s[12:15], s23 offen offset:1024 nt lds
  buffer_load_dwordx4 v6, s[12:15], s23 offen offset:2048 nt lds
  buffer_load_dwordx4 v7, s[12:15], s23 offen offset:3072 nt lds
  s_add_u32 s23, s23, 4096
  s_mov_b32 m0, s22
  s_add_u32 s22, s22, 28672
  buffer_load_dwordx4 v4, s[12:15], s23 offen offset:0 nt lds
  buffer_load_dwordx4 v5, s[12:15], s23 offen offset:1024 nt lds
  buffer_load_dwordx4 v6, s[12:15], s23 offen offset:2048 nt lds
  buffer_load_dwordx4 v7, s[12:15], s23 offen offset:3072 nt lds
  s_mov_b32 s28, s23
  s_add_u32 s63, s63, s59
  s_cmp_ge_u32 s63, s29
  s_cselect_b32 s23, s29, 0
  s_sub_u32 s63, s63, s23
  s_add_u32 s23, s62, s63
  s_lshl_b32 s23, s23, 13
  s_add_u32 s27, s27, 4
  s_barrier
L_a_kloop:
  s_waitcnt vmcnt(4)
  s_mov_b32 m0, s22
  s_add_u32 s22, s22, 4096
  buffer_load_dwordx4 v4, s[12:15], s23 offen offset:0 nt lds
  buffer_load_dwordx4 v5, s[12:15], s23 offen offset:1024 nt lds
  buffer_load_dwordx4 v6, s[12:15], s23 offen offset:2048 nt lds
  buffer_load_dwordx4 v7, s[12:15], s23 offen offset:3072 nt lds
  s_add_u32 s23, s23, 4096
  s_waitcnt vmcnt(4)
  s_mov_b32 m0, s22
  s_add_u32 s22, s22, 28672
  buffer_load_dwordx4 v4, s[12:15], s23 offen offset:0 nt lds
  buffer_load_dwordx4 v5, s[12:15], s23 offen offset:1024 nt lds
  buffer_load_dwordx4 v6, s[12:15], s23 offen offset:2048 nt lds
  buffer_load_dwordx4 v7, s[12:15], s23 offen offset:3072 nt lds
  s_mov_b32 s28, s23
  s_add_u32 s63, s63, s59
  s_cmp_ge_u32 s63, s29
  s_cselect_b32 s23, s29, 0
  s_sub_u32 s63, s63, s23
  s_add_u32 s23, s62, s63
  s_lshl_b32 s23, s23, 13
  s_add_u32 s27, s27, 4
  s_cmp_lt_u32 s27, s29
  s_cbranch_scc1 L_a_kloop
  s_branch L_a_kdone
L_vwave:
  s_barrier
  s_cmp_ge_u32 s27, s29
  s_cbranch_scc1 L_exit
L_v_ld:
  s_mov_b64 s[12:13], s[36:37]
  s_sub_u32 s26, s3, 4
  s_mov_b32 s30, 0
L_lw_1:
  s_add_u32 s30, s30, 1
  s_cmp_gt_u32 s30, 524288
  s_cbranch_scc1 L_lw_2
  ds_read_b32 v10, v3 offset:8
  s_waitcnt lgkmcnt(0)
  v_readfirstlane_b32 s25, v10
  s_cmp_ge_u32 s25, s26
  s_cbranch_scc1 L_lw_2
  s_sleep 1
  s_branch L_lw_1
L_lw_2:
  s_add_u32 s27, s28, 4096
  buffer_load_dwordx4 v[12:15], v8, s[12:15], s28 offen offset:0 nt
  buffer_load_dwordx4 v[16:19], v8, s[12:15], s28 offen offset:256 nt
  buffer_load_dwordx4 v[20:23], v8, s[12:15], s28 offen offset:512 nt
  buffer_load_dwordx4 v[24:27], v8, s[12:15], s28 offen offset:768 nt
  buffer_load_dwordx4 v[28:31], v8, s[12:15], s27 offen offset:0 nt
  buffer_load_dwordx4 v[32:35], v8, s[12:15], s27 offen offset:256 nt
  buffer_load_dwordx4 v[36:39], v8, s[12:15], s27 offen offset:512 nt
  buffer_load_dwordx4 v[40:43], v8, s[12:15], s27 offen offset:768 nt
  s_branch L_v_go
L_w0:
  s_setprio 3
  s_lshl_b32 s61, s62, 13
  s_mov_b64 s[12:13], s[38:39]
  s_mov_b32 s14, 0x400000
  s_mov_b32 s15, 0x20000
  v_lshrrev_b32 v9, 3, v0
  v_and_b32 v10, 7, v0
  v_lshlrev_b32 v10, 7, v10
  v_lshl_add_u32 v9, v9, 13, v10
  s_lshl_b32 s27, s6, 3
  s_add_u32 s27, s27, s7
  s_add_u32 s27, s27, 2
  s_lshl_b32 s27, s27, 17
  s_lshl_b32 s29, s4, 10
  s_add_u32 s27, s27, s29
  buffer_load_dword v10, v9, s[12:15], s27 offen
  s_add_u32 s27, s27, 0x10000
  buffer_load_dword v11, v9, s[12:15], s27 offen
  s_load_dword s24, s[54:55], 0
  s_barrier
  s_branch L_w0_go
L_nonatt:
  s_sub_u32 s21, s5, 24
  s_cmp_gt_u32 s3, 3
  s_cbranch_scc1 L_na_other
  s_setprio 3
  s_mov_b64 s[16:17], s[32:33]
  s_mov_b32 s18, 0x1000
  s_mov_b32 s19, 0x20000
  s_mov_b64 s[12:13], s[38:39]
  s_mov_b32 s14, 0x400000
  s_mov_b32 s15, 0x20000
  s_lshl_b32 s27, s3, 8
  v_lshl_add_u32 v4, v1, 4, s27
  v_lshl_add_u32 v4, v2, 10, v4
  buffer_load_dwordx4 v[8:11], v4, s[16:19], 0 offen
  v_xor_b32 v5, 0x100, v4
  buffer_load_dwordx4 v[12:15], v5, s[16:19], 0 offen
  v_xor_b32 v5, 0x200, v4
  buffer_load_dwordx4 v[16:19], v5, s[16:19], 0 offen
  v_xor_b32 v5, 0x300, v4
  buffer_load_dwordx4 v[20:23], v5, s[16:19], 0 offen
  v_mov_b32 v24, -1
  v_mov_b32 v25, -1
  v_mov_b32 v26, -1
  v_mov_b32 v27, -1
  v_lshlrev_b32 v5, 4, v0
  s_lshl_b32 s28, s4, 3
  s_add_u32 s28, s28, s21
  s_lshl_b32 s28, s28, 2
  s_add_u32 s28, s28, s3
  s_lshl_b32 s28, s28, 10
  s_add_u32 s28, s28, 393216
  buffer_store_dwordx4 v[24:27], v5, s[8:11], s28 offen
  s_load_dword s24, s[54:55], 0
  v_lshrrev_b32 v104, 3, v0
  v_and_b32 v105, 7, v0
  v_and_b32 v106, 2, v104
  v_xor_b32 v105, v105, v106
  v_lshlrev_b32 v105, 4, v105
  v_lshl_add_u32 v104, v104, 13, v105
  v_xor_b32 v105, 64, v104
  s_lshl_b32 s27, s3, 20
  s_lshl_b32 s28, s4, 10
  s_add_u32 s27, s27, s28
  s_lshl_b32 s28, s21, 7
  s_add_u32 s27, s27, s28
  s_lshl_b32 s31, s3, 14
  s_add_u32 s31, s31, 40960
  s_mov_b32 s22, s31
  s_mov_b32 s23, 0
L_qdma:
  s_mov_b32 m0, s22
  s_add_u32 s22, s22, 1024
  buffer_load_dwordx4 v104, s[12:15], s27 offen  lds
  s_add_u32 s27, s27, 0x10000
  s_mov_b32 m0, s22
  s_add_u32 s22, s22, 1024
  buffer_load_dwordx4 v105, s[12:15], s27 offen  lds
  s_add_u32 s27, s27, 0x10000
  s_add_u32 s23, s23, 1
  s_cmp_lg_u32 s23, 3
  s_cbranch_scc1 L_qdma2
  s_barrier
L_qdma2:
  s_cmp_lt_u32 s23, 8
  s_cbranch_scc1 L_qdma
  s_mov_b32 s23, 0xffff0000
  s_waitcnt vmcnt(17)
  v_lshlrev_b32 v24, 16, v8
  v_and_b32 v25, s23, v8
  v_lshlrev_b32 v26, 16, v9
  v_and_b32 v27, s23, v9
  v_lshlrev_b32 v28, 16, v10
  v_and_b32 v29, s23, v10
  v_lshlrev_b32 v30, 16, v11
  v_and_b32 v31, s23, v11
  v_lshlrev_b32 v32, 16, v12
  v_and_b32 v33, s23, v12
  v_lshlrev_b32 v34, 16, v13
  v_and_b32 v35, s23, v13
  v_lshlrev_b32 v36, 16, v14
  v_and_b32 v37, s23, v14
  v_lshlrev_b32 v38, 16, v15
  v_and_b32 v39, s23, v15
  v_lshlrev_b32 v40, 16, v16
  v_and_b32 v41, s23, v16
  v_lshlrev_b32 v42, 16, v17
  v_and_b32 v43, s23, v17
  v_lshlrev_b32 v44, 16, v18
  v_and_b32 v45, s23, v18
  v_lshlrev_b32 v46, 16, v19
  v_and_b32 v47, s23, v19
  v_lshlrev_b32 v48, 16, v20
  v_and_b32 v49, s23, v20
  v_lshlrev_b32 v50, 16, v21
  v_and_b32 v51, s23, v21
  v_lshlrev_b32 v52, 16, v22
  v_and_b32 v53, s23, v22
  v_lshlrev_b32 v54, 16, v23
  v_and_b32 v55, s23, v23
  s_waitcnt lgkmcnt(0)
  s_add_u32 s24, s24, 1
  s_and_b32 s30, s24, 0xff
  s_cselect_b32 s30, 0, 1
  s_add_u32 s24, s24, s30
  v_pk_add_f32 v[56:57], v[24:25], v[40:41]
  v_pk_add_f32 v[58:59], v[26:27], v[42:43]
  v_pk_add_f32 v[60:61], v[28:29], v[44:45]
  v_pk_add_f32 v[62:63], v[30:31], v[46:47]
  v_pk_add_f32 v[64:65], v[32:33], v[48:49]
  v_pk_add_f32 v[66:67], v[34:35], v[50:51]
  v_pk_add_f32 v[68:69], v[36:37], v[52:53]
  v_pk_add_f32 v[70:71], v[38:39], v[54:55]
  v_pk_add_f32 v[56:57], v[56:57], v[64:65]
  v_pk_add_f32 v[58:59], v[58:59], v[66:67]
  v_pk_add_f32 v[60:61], v[60:61], v[68:69]
  v_pk_add_f32 v[62:63], v[62:63], v[70:71]
  v_pk_add_f32 v[56:57], v[56:57], v[60:61]
  v_pk_add_f32 v[58:59], v[58:59], v[62:63]
  v_pk_add_f32 v[56:57], v[56:57], v[58:59]
  v_add_f32 v56, v56, v57
  s_nop 1
  v_add_f32_dpp v56, v56, v56 row_ror:8 row_mask:0xf bank_mask:0xf
  s_nop 1
  v_add_f32_dpp v56, v56, v56 row_ror:4 row_mask:0xf bank_mask:0xf
  s_nop 1
  v_add_f32_dpp v56, v56, v56 row_ror:2 row_mask:0xf bank_mask:0xf
  s_nop 1
  v_add_f32_dpp v56, v56, v56 row_ror:1 row_mask:0xf bank_mask:0xf
  v_mul_f32 v72, 0x3b000000, v56
  v_pk_add_f32 v[56:57], v[24:25], v[72:73] op_sel_hi:[1,0] neg_lo:[0,1] neg_hi:[0,1]
  v_pk_mul_f32 v[74:75], v[56:57], v[56:57]
  v_pk_add_f32 v[58:59], v[26:27], v[72:73] op_sel_hi:[1,0] neg_lo:[0,1] neg_hi:[0,1]
  v_pk_mul_f32 v[76:77], v[58:59], v[58:59]
  v_pk_add_f32 v[60:61], v[28:29], v[72:73] op_sel_hi:[1,0] neg_lo:[0,1] neg_hi:[0,1]
  v_pk_fma_f32 v[74:75], v[60:61], v[60:61], v[74:75]
  v_pk_add_f32 v[62:63], v[30:31], v[72:73] op_sel_hi:[1,0] neg_lo:[0,1] neg_hi:[0,1]
  v_pk_fma_f32 v[76:77], v[62:63], v[62:63], v[76:77]
  v_pk_add_f32 v[56:57], v[32:33], v[72:73] op_sel_hi:[1,0] neg_lo:[0,1] neg_hi:[0,1]
  v_pk_fma_f32 v[74:75], v[56:57], v[56:57], v[74:75]
  v_pk_add_f32 v[58:59], v[34:35], v[72:73] op_sel_hi:[1,0] neg_lo:[0,1] neg_hi:[0,1]
  v_pk_fma_f32 v[76:77], v[58:59], v[58:59], v[76:77]
  v_pk_add_f32 v[60:61], v[36:37], v[72:73] op_sel_hi:[1,0] neg_lo:[0,1] neg_hi:[0,1]
  v_pk_fma_f32 v[74:75], v[60:61], v[60:61], v[74:75]
  v_pk_add_f32 v[62:63], v[38:39], v[72:73] op_sel_hi:[1,0] neg_lo:[0,1] neg_hi:[0,1]
  v_pk_fma_f32 v[76:77], v[62:63], v[62:63], v[76:77]
  v_pk_add_f32 v[56:57], v[40:41], v[72:73] op_sel_hi:[1,0] neg_lo:[0,1] neg_hi:[0,1]
  v_pk_fma_f32 v[74:75], v[56:57], v[56:57], v[74:75]
  v_pk_add_f32 v[58:59], v[42:43], v[72:73] op_sel_hi:[1,0] neg_lo:[0,1] neg_hi:[0,1]
  v_pk_fma_f32 v[76:77], v[58:59], v[58:59], v[76:77]
  v_pk_add_f32 v[60:61], v[44:45], v[72:73] op_sel_hi:[1,0] neg_lo:[0,1] neg_hi:[0,1]
  v_pk_fma_f32 v[74:75], v[60:61], v[60:61], v[74:75]
  v_pk_add_f32 v[62:63], v[46:47], v[72:73] op_sel_hi:[1,0] neg_lo:[0,1] neg_hi:[0,1]
  v_pk_fma_f32 v[76:77], v[62:63], v[62:63], v[76:77]
  v_pk_add_f32 v[56:57], v[48:49], v[72:73] op_sel_hi:[1,0] neg_lo:[0,1] neg_hi:[0,1]
  v_pk_fma_f32 v[74:75], v[56:57], v[56:57], v[74:75]
  v_pk_add_f32 v[58:59], v[50:51], v[72:73] op_sel_hi:[1,0] neg_lo:[0,1] neg_hi:[0,1]
  v_pk_fma_f32 v[76:77], v[58:59], v[58:59], v[76:77]
  v_pk_add_f32 v[60:61], v[52:53], v[72:73] op_sel_hi:[1,0] neg_lo:[0,1] neg_hi:[0,1]
  v_pk_fma_f32 v[74:75], v[60:61], v[60:61], v[74:75]
  v_pk_add_f32 v[62:63], v[54:55], v[72:73] op_sel_hi:[1,0] neg_lo:[0,1] neg_hi:[0,1]
  v_pk_fma_f32 v[76:77], v[62:63], v[62:63], v[76:77]
  v_pk_add_f32 v[74:75], v[74:75], v[76:77]
  v_add_f32 v74, v74, v75
  s_nop 1
  v_add_f32_dpp v74, v74, v74 row_ror:8 row_mask:0xf bank_mask:0xf
  s_nop 1
  v_add_f32_dpp v74, v74, v74 row_ror:4 row_mask:0xf bank_mask:0xf
  s_nop 1
  v_add_f32_dpp v74, v74, v74 row_ror:2 row_mask:0xf bank_mask:0xf
  s_nop 1
  v_add_f32_dpp v74, v74, v74 row_ror:1 row_mask:0xf bank_mask:0xf
  v_mul_f32 v74, 0x3b000000, v74
  v_cvt_pk_bf16_f32 v75, v72, v74
  v_lshlrev_b32 v72, 16, v75
  v_and_b32 v74, s23, v75
  v_add_f32 v74, 0x3727c5ac, v74
  v_cvt_pk_bf16_f32 v74, v74, v74
  v_and_b32 v74, s23, v74
  v_sqrt_f32 v74, v74
  s_nop 0
  v_cvt_pk_bf16_f32 v74, v74, v74
  v_and_b32 v74, s23, v74
  v_rcp_f32 v74, v74
  v_pk_add_f32 v[24:25], v[24:25], v[72:73] op_sel_hi:[1,0] neg_lo:[0,1] neg_hi:[0,1]
  v_pk_add_f32 v[26:27], v[26:27], v[72:73] op_sel_hi:[1,0] neg_lo:[0,1] neg_hi:[0,1]
  v_pk_add_f32 v[28:29], v[28:29], v[72:73] op_sel_hi:[1,0] neg_lo:[0,1] neg_hi:[0,1]
  v_pk_add_f32 v[30:31], v[30:31], v[72:73] op_sel_hi:[1,0] neg_lo:[0,1] neg_hi:[0,1]
  v_cvt_pk_bf16_f32 v8, v24, v25
  v_cvt_pk_bf16_f32 v9, v26, v27
  v_cvt_pk_bf16_f32 v10, v28, v29
  v_cvt_pk_bf16_f32 v11, v30, v31
  v_lshlrev_b32 v24, 16, v8
  v_and_b32 v25, s23, v8
  v_lshlrev_b32 v26, 16, v9
  v_and_b32 v27, s23, v9
  v_lshlrev_b32 v28, 16, v10
  v_and_b32 v29, s23, v10
  v_lshlrev_b32 v30, 16, v11
  v_and_b32 v31, s23, v11
  v_pk_mul_f32 v[24:25], v[24:25], v[74:75] op_sel_hi:[1,0]
  v_pk_mul_f32 v[26:27], v[26:27], v[74:75] op_sel_hi:[1,0]
  v_pk_mul_f32 v[28:29], v[28:29], v[74:75] op_sel_hi:[1,0]
  v_pk_mul_f32 v[30:31], v[30:31], v[74:75] op_sel_hi:[1,0]
  v_cvt_pk_bf16_f32 v8, v24, v25
  v_cvt_pk_bf16_f32 v9, v26, v27
  v_cvt_pk_bf16_f32 v10, v28, v29
  v_cvt_pk_bf16_f32 v11, v30, v31
  s_lshl_b32 s27, s3, 10
  v_lshl_add_u32 v7, v0, 4, s27
  ds_write_b128 v7, v[8:11] offset:2048
  v_bfe_u32 v12, v0, 2, 2
  v_lshl_add_u32 v5, v12, 8, s27
  v_lshl_add_u32 v5, v2, 4, v5
  ds_read_b128 v[72:75], v5 offset:2048
  ds_read_b128 v[76:79], v5 offset:2112
  ds_read_b128 v[80:83], v5 offset:2176
  ds_read_b128 v[84:87], v5 offset:2240
  v_and_b32 v13, 3, v0
  v_lshlrev_b32 v104, 10, v2
  v_lshl_add_u32 v104, v12, 7, v104
  v_lshl_add_u32 v104, v13, 3, v104
  v_lshrrev_b32 v12, 1, v12
  v_and_b32 v14, 1, v2
  v_lshl_add_u32 v12, v14, 1, v12
  v_lshl_add_u32 v104, v12, 5, v104
  v_add_u32 v104, s31, v104
  v_xor_b32 v105, 32, v104
  v_xor_b32 v106, 64, v104
  v_xor_b32 v107, 0x60, v104
  s_lshl_b32 s27, s4, 14
  s_add_u32 s27, s27, 65536
  s_lshl_b32 s28, s21, 8
  s_add_u32 s27, s27, s28
  v_lshlrev_b32 v5, 4, v1
  v_lshl_add_u32 v5, v2, 11, v5
  s_waitcnt vmcnt(12)
  ds_read_b64_tr_b16 v[8:9], v104 offset:0
  ds_read_b64_tr_b16 v[10:11], v104 offset:512
  ds_read_b64_tr_b16 v[12:13], v105 offset:0
  ds_read_b64_tr_b16 v[14:15], v105 offset:512
  ds_read_b64_tr_b16 v[16:17], v106 offset:0
  ds_read_b64_tr_b16 v[18:19], v106 offset:512
  ds_read_b64_tr_b16 v[20:21], v107 offset:0
  ds_read_b64_tr_b16 v[22:23], v107 offset:512
  s_waitcnt lgkmcnt(0)
  s_waitcnt vmcnt(8)
  ds_read_b64_tr_b16 v[24:25], v104 offset:4096
  ds_read_b64_tr_b16 v[26:27], v104 offset:4608
  ds_read_b64_tr_b16 v[28:29], v105 offset:4096
  ds_read_b64_tr_b16 v[30:31], v105 offset:4608
  ds_read_b64_tr_b16 v[32:33], v106 offset:4096
  ds_read_b64_tr_b16 v[34:35], v106 offset:4608
  ds_read_b64_tr_b16 v[36:37], v107 offset:4096
  ds_read_b64_tr_b16 v[38:39], v107 offset:4608
  v_mfma_f32_16x16x32_bf16 v[56:59], v[72:75], v[8:11], 0
  v_mfma_f32_16x16x32_bf16 v[60:63], v[72:75], v[12:15], 0
  v_mfma_f32_16x16x32_bf16 v[64:67], v[72:75], v[16:19], 0
  v_mfma_f32_16x16x32_bf16 v[68:71], v[72:75], v[20:23], 0
  s_waitcnt lgkmcnt(0)
  s_waitcnt vmcnt(4)
  ds_read_b64_tr_b16 v[8:9], v104 offset:8192
  ds_read_b64_tr_b16 v[10:11], v104 offset:8704
  ds_read_b64_tr_b16 v[12:13], v105 offset:8192
  ds_read_b64_tr_b16 v[14:15], v105 offset:8704
  ds_read_b64_tr_b16 v[16:17], v106 offset:8192
  ds_read_b64_tr_b16 v[18:19], v106 offset:8704
  ds_read_b64_tr_b16 v[20:21], v107 offset:8192
  ds_read_b64_tr_b16 v[22:23], v107 offset:8704
  v_mfma_f32_16x16x32_bf16 v[56:59], v[76:79], v[24:27], v[56:59]
  v_mfma_f32_16x16x32_bf16 v[60:63], v[76:79], v[28:31], v[60:63]
  v_mfma_f32_16x16x32_bf16 v[64:67], v[76:79], v[32:35], v[64:67]
  v_mfma_f32_16x16x32_bf16 v[68:71], v[76:79], v[36:39], v[68:71]
  s_waitcnt lgkmcnt(0)
  s_waitcnt vmcnt(0)
  ds_read_b64_tr_b16 v[24:25], v104 offset:12288
  ds_read_b64_tr_b16 v[26:27], v104 offset:12800
  ds_read_b64_tr_b16 v[28:29], v105 offset:12288
  ds_read_b64_tr_b16 v[30:31], v105 offset:12800
  ds_read_b64_tr_b16 v[32:33], v106 offset:12288
  ds_read_b64_tr_b16 v[34:35], v106 offset:12800
  ds_read_b64_tr_b16 v[36:37], v107 offset:12288
  ds_read_b64_tr_b16 v[38:39], v107 offset:12800
  v_mfma_f32_16x16x32_bf16 v[56:59], v[80:83], v[8:11], v[56:59]
  v_mfma_f32_16x16x32_bf16 v[60:63], v[80:83], v[12:15], v[60:63]
  v_mfma_f32_16x16x32_bf16 v[64:67], v[80:83], v[16:19], v[64:67]
  v_mfma_f32_16x16x32_bf16 v[68:71], v[80:83], v[20:23], v[68:71]
  s_waitcnt lgkmcnt(0)
  v_mfma_f32_16x16x32_bf16 v[56:59], v[84:87], v[24:27], v[56:59]
  v_mfma_f32_16x16x32_bf16 v[60:63], v[84:87], v[28:31], v[60:63]
  v_mfma_f32_16x16x32_bf16 v[64:67], v[84:87], v[32:35], v[64:67]
  v_mfma_f32_16x16x32_bf16 v[68:71], v[84:87], v[36:39], v[68:71]
  s_nop 5
  v_mov_b32 v57, v60
  v_mov_b32 v58, v64
  v_mov_b32 v59, v68
  ds_write_b128 v7, v[56:59] offset:8192
  v_mov_b32 v8, 1
  s_mov_b64 exec, 1
  ds_add_u32 v3, v8 offset:4
  s_mov_b64 exec, -1
  s_cmp_lg_u32 s3, 0
  s_cbranch_scc1 L_ffn
  s_mov_b32 s30, 0
L_qp_spin:
  s_add_u32 s30, s30, 1
  s_cmp_gt_u32 s30, 524288
  s_cbranch_scc1 L_qp_ok
  ds_read_b32 v8, v3 offset:4
  ds_read_b128 v[12:15], v7 offset:9216
  ds_read_b128 v[16:19], v7 offset:10240
  ds_read_b128 v[20:23], v7 offset:11264
  s_waitcnt lgkmcnt(0)
  v_readfirstlane_b32 s28, v8
  s_cmp_lt_u32 s28, 4
  s_cbranch_scc1 L_qp_spin
L_qp_ok:
  v_pk_add_f32 v[56:57], v[56:57], v[12:13]
  v_pk_add_f32 v[16:17], v[16:17], v[20:21]
  v_pk_add_f32 v[58:59], v[58:59], v[14:15]
  v_pk_add_f32 v[18:19], v[18:19], v[22:23]
  v_pk_add_f32 v[56:57], v[56:57], v[16:17]
  v_pk_add_f32 v[58:59], v[58:59], v[18:19]
  v_cvt_pk_bf16_f32 v8, v56, v57
  v_cvt_pk_bf16_f32 v10, v58, v59
  v_mov_b32 v9, s24
  v_mov_b32 v11, s24
  buffer_store_dwordx4 v[8:11], v5, s[8:11], s27 offen
  s_add_u32 s27, s27, 131072
  buffer_store_dwordx4 v[8:11], v5, s[8:11], s27 offen sc1
  v_mov_b32 v12, 1
  s_mov_b64 exec, 1
  ds_add_u32 v3, v12 offset:12
  s_mov_b64 exec, -1
  s_branch L_ffn
L_na_other:
  s_barrier
  s_cmp_lt_u32 s3, 8
  s_cbranch_scc1 L_ffn
  v_lshlrev_b32 v5, 4, v0
  v_mov_b32 v8, -1
  v_mov_b32 v9, -1
  v_mov_b32 v10, -1
  v_mov_b32 v11, -1
  s_cmp_eq_u32 s3, 15
  s_cbranch_scc1 L_na_w15
  s_cmp_lg_u32 s3, 10
  s_cbranch_scc1 L_exit
  s_mov_b64 s[12:13], s[40:41]
  s_mov_b32 s14, 0x400000
  s_mov_b32 s15, 0x20000
  v_lshlrev_b32 v6, 7, v0
  s_lshl_b32 s28, s4, 3
  s_add_u32 s28, s28, s21
  s_lshl_b32 s28, s28, 16
  s_mov_b32 s30, 0
L_lw_3:
  s_add_u32 s30, s30, 1
  s_cmp_gt_u32 s30, 524288
  s_cbranch_scc1 L_lw_4
  ds_read_b32 v12, v3 offset:12
  s_waitcnt lgkmcnt(0)
  v_readfirstlane_b32 s27, v12
  s_cmp_ge_u32 s27, 1
  s_cbranch_scc1 L_lw_4
  s_sleep 4
  s_branch L_lw_3
L_lw_4:
  v_lshlrev_b32 v6, 10, v0
  buffer_load_dword v16, v6, s[12:15], s28 offen offset:384
  s_endpgm
L_na_w15:
  s_load_dword s24, s[54:55], 0
  s_lshl_b32 s29, s4, 14
  s_add_u32 s29, s29, 65536
  s_cmp_eq_u32 s5, 31
  s_cbranch_scc0 L_h_wait
  v_lshlrev_b32 v7, 7, v0
  buffer_load_dword v14, v7, s[8:11], s29 offen sc1
L_h_wait:
  s_getreg_b32 s25, hwreg(HW_REG_XCC_ID, 0, 4)
  s_lshl_b32 s60, s4, 14
  s_add_u32 s60, s60, 65536
  s_lshl_b32 s30, s5, 3
  s_add_u32 s60, s60, s30
  s_add_u32 s60, s60, 8448
  v_mov_b32 v16, s25
  s_waitcnt lgkmcnt(0)
  s_add_u32 s24, s24, 1
  s_and_b32 s30, s24, 0xff
  s_cselect_b32 s30, 0, 1
  s_add_u32 s24, s24, s30
  v_mov_b32 v17, s24
  s_mov_b64 exec, 1
  buffer_store_dwordx2 v[16:17], v3, s[8:11], s60 offen
  s_add_u32 s60, s60, 131072
  s_mov_b64 exec, -1
  v_lshrrev_b32 v6, 5, v0
  v_mul_u32_u24 v6, 131072, v6
  v_and_b32 v7, 31, v0
  v_lshlrev_b32 v7, 3, v7
  v_add_u32 v7, 8448, v7
  v_and_b32 v18, 7, v0
  v_lshl_add_u32 v18, v18, 8, v6
  v_add_u32 v6, v6, v7
  s_mov_b32 s30, 0
L_lw_5:
  s_add_u32 s30, s30, 1
  s_cmp_gt_u32 s30, 524288
  s_cbranch_scc1 L_lw_6
  ds_read_b32 v12, v3 offset:12
  s_waitcnt lgkmcnt(0)
  v_readfirstlane_b32 s28, v12
  s_cmp_ge_u32 s28, 1
  s_cbranch_scc1 L_lw_6
  s_sleep 8
  s_branch L_lw_5
L_lw_6:
  s_mov_b32 s30, 0
L_h_p:
  s_add_u32 s30, s30, 1
  s_cmp_gt_u32 s30, 524288
  s_cbranch_scc1 L_h_ok
  s_cmp_lg_u32 s30, 10
  s_cbranch_scc1 L_h_loc
  v_mov_b32 v7, v6
  s_mov_b64 exec, 1
  buffer_store_dwordx2 v[16:17], v3, s[8:11], s60 offen sc1
  s_mov_b64 exec, -1
L_h_loc:
  buffer_load_dwordx2 v[14:15], v7, s[8:11], s29 offen sc1
  s_waitcnt vmcnt(0)
L_h_chk:
  v_cmp_eq_u32 vcc, s24, v15
  s_or_b32 s26, vcc_lo, vcc_hi
  s_cmp_lg_u32 s26, -1
  s_cbranch_scc1 L_h_p
L_h_ok:
  v_cmp_ne_u32 s[62:63], s25, v14
  s_and_b64 s[62:63], s[62:63], vcc
  s_mov_b32 s26, 2
  s_cbranch_scc0 L_h_fin
  s_mov_b32 s26, 1
  s_mov_b64 exec, 1
  buffer_store_dwordx2 v[16:17], v3, s[8:11], s60 offen sc1
  s_mov_b64 exec, -1
  s_add_u32 s62, s29, 139264
  s_cmp_lg_u32 s5, 31
  s_cbranch_scc1 L_h_gs
  s_lshl_b32 s27, s4, 15
  s_add_u32 s27, s27, 655360
  s_mov_b32 s28, 0
L_clr_loop:
  buffer_store_dwordx4 v[8:11], v5, s[8:11], s27 offen offset:0 sc1
  buffer_store_dwordx4 v[8:11], v5, s[8:11], s27 offen offset:1024 sc1
  buffer_store_dwordx4 v[8:11], v5, s[8:11], s27 offen offset:2048 sc1
  buffer_store_dwordx4 v[8:11], v5, s[8:11], s27 offen offset:3072 sc1
  s_add_u32 s27, s27, 4096
  s_add_u32 s28, s28, 1
  s_cmp_lt_u32 s28, 8
  s_cbranch_scc1 L_clr_loop
  s_waitcnt vmcnt(0)
  s_mov_b64 exec, 1
  buffer_store_dwordx2 v[16:17], v3, s[8:11], s62 offen sc1
  s_mov_b64 exec, -1
  s_branch L_h_fin
L_h_gs:
  s_mov_b32 s30, 0
L_h_gp:
  s_add_u32 s30, s30, 1
  s_cmp_gt_u32 s30, 524288
  s_cbranch_scc1 L_h_fin
  buffer_load_dwordx2 v[14:15], v3, s[8:11], s62 offen sc1
  s_waitcnt vmcnt(0)
  v_cmp_eq_u32 vcc, s24, v15
  s_cbranch_vccz L_h_gp
L_h_fin:
  s_cmp_lg_u32 s26, 2
  s_cbranch_scc1 L_gs_ok
  s_mov_b32 exec_hi, 0
  s_mov_b32 s30, 0
L_gs_poll:
  s_add_u32 s30, s30, 1
  s_cmp_gt_u32 s30, 524288
  s_cbranch_scc1 L_gs_ok
  buffer_load_dwordx2 v[14:15], v18, s[8:11], s29 offen sc1
  s_waitcnt vmcnt(0)
  v_cmp_ne_u32 vcc, s24, v15
  s_cbranch_vccnz L_gs_poll
L_gs_ok:
  s_mov_b64 exec, -1
  ds_write_b32 v3, v17 offset:24
  v_mov_b32 v12, s26
  ds_write_b32 v3, v12 offset:20
  s_lshl_b32 s29, s4, 15
  s_add_u32 s29, s29, 393216
  s_and_b32 s28, s26, 1
  s_lshl_b32 s28, s28, 18
  s_add_u32 s29, s29, s28
  v_min_u32 v7, 23, v0
  v_lshlrev_b32 v7, 6, v7
  v_cmp_lt_u32 vcc, 11, v0
  v_mov_b32 v14, 2304
  s_nop 0
  v_cndmask_b32 v14, 0, v14, vcc
  v_add_u32 v7, v7, v14
  s_lshl_b32 s27, s21, 12
  v_lshl_add_u32 v6, v0, 6, s27
  s_mov_b32 s30, 0
L_t_poll:
  s_add_u32 s30, s30, 1
  s_cmp_gt_u32 s30, 524288
  s_cbranch_scc1 L_t_ok
  buffer_load_dword v15, v6, s[8:11], s29 offen sc1
  buffer_load_dword v14, v7, s[8:11], s29 offen sc1
  s_waitcnt vmcnt(0)
  v_cmp_ne_u32 vcc, -1, v14
  s_and_b32 s28, vcc_lo, 0xffffff
  s_bcnt1_i32_b32 s28, s28
  s_cmp_lt_u32 s28, 1
  s_cbranch_scc1 L_t_poll
L_t_ok:
  v_mov_b32 v12, 1
  ds_write_b32 v3, v12 offset:0
  s_endpgm
L_v_go:
  v_lshrrev_b32 v5, 2, v1
  v_lshl_add_u32 v5, v5, 6, s31
  v_lshl_add_u32 v5, v2, 4, v5
  v_lshl_add_u32 v6, v0, 2, s31
  s_mov_b32 s16, 0x05040100
  s_mov_b32 s17, 0x07060302
  ds_read_b32 v7, v3 offset:12
  ds_read_b128 v[8:11], v5
  s_waitcnt lgkmcnt(0)
  v_readfirstlane_b32 s25, v7
  s_waitcnt vmcnt(6)
  v_perm_b32 v44, v16, v12, s16
  v_perm_b32 v48, v16, v12, s17
  v_perm_b32 v52, v17, v13, s16
  v_perm_b32 v56, v17, v13, s17
  v_perm_b32 v60, v18, v14, s16
  v_perm_b32 v64, v18, v14, s17
  v_perm_b32 v68, v19, v15, s16
  v_perm_b32 v72, v19, v15, s17
  s_waitcnt vmcnt(4)
  v_perm_b32 v45, v24, v20, s16
  v_perm_b32 v49, v24, v20, s17
  v_perm_b32 v53, v25, v21, s16
  v_perm_b32 v57, v25, v21, s17
  v_perm_b32 v61, v26, v22, s16
  v_perm_b32 v65, v26, v22, s17
  v_perm_b32 v69, v27, v23, s16
  v_perm_b32 v73, v27, v23, s17
  s_waitcnt vmcnt(2)
  v_mov_b32 v7, 1
  s_mov_b64 exec, 1
  ds_add_u32 v3, v7 offset:8
  s_mov_b64 exec, -1
  v_perm_b32 v46, v32, v28, s16
  v_perm_b32 v50, v32, v28, s17
  v_perm_b32 v54, v33, v29, s16
  v_perm_b32 v58, v33, v29, s17
  v_perm_b32 v62, v34, v30, s16
  v_perm_b32 v66, v34, v30, s17
  v_perm_b32 v70, v35, v31, s16
  v_perm_b32 v74, v35, v31, s17
  s_cmp_ge_u32 s25, 4
  s_cbranch_scc1 L_v_pok
  s_mov_b32 s30, 0
L_lw_7:
  s_add_u32 s30, s30, 1
  s_cmp_gt_u32 s30, 524288
  s_cbranch_scc1 L_lw_8
  ds_read_b32 v7, v3 offset:12
  s_waitcnt lgkmcnt(0)
  v_readfirstlane_b32 s25, v7
  s_cmp_ge_u32 s25, 4
  s_cbranch_scc1 L_lw_8
  s_sleep 2
  s_branch L_lw_7
L_lw_8:
  ds_read_b128 v[8:11], v5
L_v_pok:
  s_cmp_eq_u32 s29, 12
  s_cselect_b32 s27, 11, s29
  s_cmp_le_u32 s3, s27
  s_cselect_b32 s27, 32, 36
  v_mov_b32 v4, s27
  v_mov_b32 v7, 1
  s_setprio 3
  s_waitcnt vmcnt(0) lgkmcnt(0)
  v_perm_b32 v47, v40, v36, s16
  v_perm_b32 v51, v40, v36, s17
  v_perm_b32 v55, v41, v37, s16
  v_mfma_f32_16x16x32_bf16 v[76:79], v[8:11], v[44:47], 0
  v_perm_b32 v59, v41, v37, s17
  v_mfma_f32_16x16x32_bf16 v[80:83], v[8:11], v[48:51], 0
  v_perm_b32 v63, v42, v38, s16
  v_mfma_f32_16x16x32_bf16 v[84:87], v[8:11], v[52:55], 0
  v_perm_b32 v67, v42, v38, s17
  v_mfma_f32_16x16x32_bf16 v[88:91], v[8:11], v[56:59], 0
  v_perm_b32 v71, v43, v39, s16
  v_mfma_f32_16x16x32_bf16 v[92:95], v[8:11], v[60:63], 0
  v_perm_b32 v75, v43, v39, s17
  v_mfma_f32_16x16x32_bf16 v[96:99], v[8:11], v[64:67], 0
  v_mfma_f32_16x16x32_bf16 v[100:103], v[8:11], v[68:71], 0
  ds_write2st64_b32 v6, v76, v80 offset0:4 offset1:5
  v_mfma_f32_16x16x32_bf16 v[104:107], v[8:11], v[72:75], 0
  s_nop 0
  ds_write2st64_b32 v6, v84, v88 offset0:6 offset1:7
  s_nop 2
  ds_write2st64_b32 v6, v92, v96 offset0:8 offset1:9
  s_nop 1
  ds_write2st64_b32 v6, v100, v104 offset0:10 offset1:11
  s_mov_b64 exec, 1
  ds_add_u32 v4, v7
  s_mov_b64 exec, -1
  s_cmp_gt_u32 s3, 8
  s_cbranch_scc1 L_exit
  s_sub_u32 s19, s3, 5
  s_lshl_b32 s23, s19, 9
  s_add_u32 s23, s23, 41984
  v_lshl_add_u32 v108, v0, 2, s23
  s_sub_u32 s29, s29, 4
  s_min_u32 s23, s29, 7
  s_lshl_b32 s23, s23, 13
  v_add_u32 v109, s23, v108
  v_mul_u32_u24 v107, 6144, v2
  v_lshl_add_u32 v107, v1, 2, v107
  s_lshl_b32 s31, s4, 15
  s_add_u32 s31, s31, 393216
  s_cmp_ge_u32 s7, 3
  s_cselect_b32 s23, 2880, 0
  s_mul_i32 s27, s6, 3
  s_add_u32 s27, s27, s7
  s_lshl_b32 s27, s27, 6
  s_add_u32 s23, s23, s27
  s_mul_i32 s27, s19, 768
  s_add_u32 s23, s23, s27
  s_add_u32 s23, s23, s31
  v_mov_b32 v24, 0
  v_mov_b32 v25, 0
  v_mov_b32 v26, 0
  v_mov_b32 v27, 0
  s_setprio 1
  s_mov_b32 s30, 0
L_lw_9:
  s_add_u32 s30, s30, 1
  s_cmp_gt_u32 s30, 524288
  s_cbranch_scc1 L_lw_10
  ds_read_b32 v7, v3 offset:32
  s_waitcnt lgkmcnt(0)
  v_readfirstlane_b32 s25, v7
  s_cmp_ge_u32 s25, s29
  s_cbranch_scc1 L_lw_10
  s_sleep 2
  s_branch L_lw_9
L_lw_10:
  ds_read2st64_b32 v[12:13], v108 offset0:0 offset1:1
  ds_read2st64_b32 v[14:15], v108 offset0:32 offset1:33
  ds_read2st64_b32 v[16:17], v108 offset0:64 offset1:65
  ds_read2st64_b32 v[18:19], v108 offset0:96 offset1:97
  ds_read2st64_b32 v[20:21], v108 offset0:128 offset1:129
  ds_read2st64_b32 v[22:23], v108 offset0:160 offset1:161
  s_cmp_lt_u32 s29, 8
  s_cbranch_scc1 L_o_e6
  ds_read2st64_b32 v[24:25], v108 offset0:192 offset1:193
  ds_read2st64_b32 v[26:27], v109 offset0:128 offset1:129
L_o_e6:
  s_mov_b32 s30, 0
L_lw_11:
  s_add_u32 s30, s30, 1
  s_cmp_gt_u32 s30, 524288
  s_cbranch_scc1 L_lw_12
  ds_read_b32 v7, v3 offset:20
  s_waitcnt lgkmcnt(0)
  v_readfirstlane_b32 s26, v7
  s_cmp_ge_u32 s26, 1
  s_cbranch_scc1 L_lw_12
  s_sleep 2
  s_branch L_lw_11
L_lw_12:
  s_and_b32 s27, s26, 1
  s_lshl_b32 s27, s27, 18
  s_add_u32 s23, s23, s27
  v_pk_add_f32 v[12:13], v[12:13], v[20:21]
  v_pk_add_f32 v[14:15], v[14:15], v[22:23]
  v_pk_add_f32 v[16:17], v[16:17], v[24:25]
  v_pk_add_f32 v[18:19], v[18:19], v[26:27]
  v_pk_add_f32 v[12:13], v[12:13], v[16:17]
  v_pk_add_f32 v[14:15], v[14:15], v[18:19]
  v_pk_add_f32 v[12:13], v[12:13], v[14:15]
  s_setprio 3
  s_mov_b32 s30, 0
L_o_spin:
  s_add_u32 s30, s30, 1
  s_cmp_gt_u32 s30, 524288
  s_cbranch_scc1 L_o_go
  ds_read_b32 v7, v3 offset:36
  ds_read2st64_b32 v[14:15], v109 offset0:0 offset1:1
  ds_read2st64_b32 v[16:17], v109 offset0:32 offset1:33
  ds_read2st64_b32 v[18:19], v109 offset0:64 offset1:65
  ds_read2st64_b32 v[20:21], v109 offset0:96 offset1:97
  s_waitcnt lgkmcnt(0)
  v_readfirstlane_b32 s25, v7
  s_cmp_lt_u32 s25, 4
  s_cbranch_scc1 L_o_spin
L_o_go:
  v_pk_add_f32 v[12:13], v[12:13], v[14:15]
  v_pk_add_f32 v[16:17], v[16:17], v[18:19]
  v_pk_add_f32 v[12:13], v[12:13], v[20:21]
  v_pk_add_f32 v[12:13], v[12:13], v[16:17]
  v_cvt_pk_bf16_f32 v12, v12, v13
  v_min_u32 v12, -2, v12
  s_cmp_lg_u32 s26, 2
  s_cbranch_scc1 L_ls_13
  buffer_store_dword v12, v107, s[8:11], s23 offen
  s_branch L_ls_14
L_ls_13:
  buffer_store_dword v12, v107, s[8:11], s23 offen sc1
L_ls_14:
  s_cmp_ge_u32 s7, 4
  s_cbranch_scc1 L_a_fpf
  s_endpgm
L_a_kdone:
  s_sub_u32 s28, s28, 4096
  s_load_dword s24, s[54:55], 0
  s_sub_u32 s29, s29, s3
  s_sub_u32 s19, s3, 1
  s_lshl_b32 s20, s6, 2
  s_add_u32 s20, s20, s7
  s_lshr_b32 s21, s20, 1
  s_and_b32 s20, s20, 1
  s_cmp_eq_u32 s29, 8
  s_cselect_b32 s27, s7, 0
  s_cmp_lt_u32 s27, 4
  s_cbranch_scc1 L_a_nov
  s_mov_b64 s[12:13], s[36:37]
  s_mov_b32 s22, 8192
  s_waitcnt vmcnt(4)
  s_mov_b32 m0, s22
  s_add_u32 s22, s22, 1024
  buffer_load_dwordx4 v8, s[12:15], s28 offen nt lds
  s_add_u32 s28, s28, 256
  s_mov_b32 m0, s22
  s_add_u32 s22, s22, 1024
  buffer_load_dwordx4 v8, s[12:15], s28 offen nt lds
  s_add_u32 s28, s28, 256
  s_mov_b32 m0, s22
  s_add_u32 s22, s22, 1024
  buffer_load_dwordx4 v8, s[12:15], s28 offen nt lds
  s_add_u32 s28, s28, 256
  s_mov_b32 m0, s22
  s_add_u32 s22, s22, 1024
  buffer_load_dwordx4 v8, s[12:15], s28 offen nt lds
  s_add_u32 s28, s28, 3328
  s_waitcnt vmcnt(4)
  s_mov_b32 m0, s22
  s_add_u32 s22, s22, 1024
  buffer_load_dwordx4 v8, s[12:15], s28 offen nt lds
  s_add_u32 s28, s28, 256
  s_mov_b32 m0, s22
  s_add_u32 s22, s22, 1024
  buffer_load_dwordx4 v8, s[12:15], s28 offen nt lds
  s_add_u32 s28, s28, 256
  s_mov_b32 m0, s22
  s_add_u32 s22, s22, 1024
  buffer_load_dwordx4 v8, s[12:15], s28 offen nt lds
  s_add_u32 s28, s28, 256
  s_mov_b32 m0, s22
  s_add_u32 s22, s22, 1024
  buffer_load_dwordx4 v8, s[12:15], s28 offen nt lds
  s_add_u32 s28, s28, 256
  s_waitcnt vmcnt(8)
  s_branch L_a_kin
L_a_nov:
  s_waitcnt vmcnt(0)
  v_mov_b32 v120, 1
  s_mov_b64 exec, 1
  ds_add_u32 v3, v120 offset:8
  s_mov_b64 exec, -1
  s_waitcnt vmcnt(0)
L_a_kin:
  v_xor_b32 v4, v1, v2
  v_lshlrev_b32 v4, 4, v4
  v_lshl_add_u32 v4, v1, 8, v4
  v_add_u32 v4, s31, v4
  v_xor_b32 v5, 64, v4
  v_xor_b32 v6, 0x80, v4
  v_xor_b32 v7, 0xc0, v4
  ds_read_b128 v[24:27], v4 offset:0
  ds_read_b128 v[40:43], v4 offset:4096
  ds_read_b128 v[28:31], v5 offset:0
  ds_read_b128 v[44:47], v5 offset:4096
  ds_read_b128 v[32:35], v6 offset:0
  ds_read_b128 v[48:51], v6 offset:4096
  ds_read_b128 v[36:39], v7 offset:0
  ds_read_b128 v[52:55], v7 offset:4096
  ds_read_b128 v[56:59], v4 offset:32768
  ds_read_b128 v[72:75], v4 offset:36864
  ds_read_b128 v[60:63], v5 offset:32768
  ds_read_b128 v[76:79], v5 offset:36864
  ds_read_b128 v[64:67], v6 offset:32768
  ds_read_b128 v[80:83], v6 offset:36864
  ds_read_b128 v[68:71], v7 offset:32768
  ds_read_b128 v[84:87], v7 offset:36864
  v_lshrrev_b32 v120, 2, v1
  v_lshlrev_b32 v121, 8, v120
  v_lshl_add_u32 v121, v2, 4, v121
  v_lshl_add_u32 v122, v120, 6, s31
  v_lshl_add_u32 v122, v2, 4, v122
  v_and_b32 v123, 1, v0
  v_lshl_add_u32 v122, v123, 3, v122
  v_add_u32 v124, 0x10000, v122
  v_bfe_u32 v123, v0, 1, 1
  v_lshl_add_u32 v122, v123, 15, v122
  v_lshlrev_b32 v120, 4, v120
  s_lshl_b32 s27, s19, 2
  v_add_u32 v123, s27, v120
  v_add_u32 v4, 0x10000, v4
  v_add_u32 v5, 0x10000, v5
  v_add_u32 v6, 0x10000, v6
  v_add_u32 v7, 0x10000, v7
  v_mov_b32 v104, 0xff800000
  v_mov_b32 v105, 0xff800000
  v_mov_b32 v106, 0xff800000
  v_mov_b32 v107, 0xff800000
  s_mov_b32 s16, 0xffff0000
  s_mov_b32 s17, 0x3db504f3
  s_mov_b32 s18, 0x3fb8aa3b
  s_mov_b32 s56, 0x22222222
  s_mov_b32 s57, 0x22222222
  s_mov_b32 s58, 0x44444444
  s_mov_b32 s59, 0x44444444
  s_mov_b32 s60, 0x88888888
  s_mov_b32 s61, 0x88888888
  s_mov_b32 s62, 0xaaaaaaaa
  s_mov_b32 s63, 0xaaaaaaaa
  s_waitcnt lgkmcnt(0)
  s_add_u32 s24, s24, 1
  s_and_b32 s30, s24, 0xff
  s_cselect_b32 s30, 0, 1
  s_add_u32 s24, s24, s30
  s_setprio 2
  s_mov_b32 s30, 0
L_lw_15:
  s_add_u32 s30, s30, 1
  s_cmp_gt_u32 s30, 524288
  s_cbranch_scc1 L_lw_16
  ds_read_b32 v125, v3 offset:0
  s_waitcnt lgkmcnt(0)
  v_readfirstlane_b32 s27, v125
  s_cmp_ge_u32 s27, 1
  s_cbranch_scc1 L_lw_16
  s_sleep 1
  s_branch L_lw_15
L_lw_16:
  ds_read_b128 v[8:11], v121 offset:2048
  ds_read_b128 v[12:15], v121 offset:2112
  ds_read_b128 v[16:19], v121 offset:2176
  ds_read_b128 v[20:23], v121 offset:2240
  s_waitcnt lgkmcnt(0)
  v_mfma_f32_16x16x32_bf16 v[88:91], v[24:27], v[8:11], 0
  v_mfma_f32_16x16x32_bf16 v[92:95], v[40:43], v[8:11], 0
  v_mfma_f32_16x16x32_bf16 v[88:91], v[28:31], v[12:15], v[88:91]
  v_mfma_f32_16x16x32_bf16 v[92:95], v[44:47], v[12:15], v[92:95]
  v_mfma_f32_16x16x32_bf16 v[88:91], v[32:35], v[16:19], v[88:91]
  v_mfma_f32_16x16x32_bf16 v[92:95], v[48:51], v[16:19], v[92:95]
  v_mfma_f32_16x16x32_bf16 v[88:91], v[36:39], v[20:23], v[88:91]
  v_mfma_f32_16x16x32_bf16 v[92:95], v[52:55], v[20:23], v[92:95]
  s_cmp_le_u32 s29, 7
  s_cbranch_scc1 L_a_no3a
  ds_read_b128 v[24:27], v4 offset:0
  ds_read_b128 v[40:43], v4 offset:4096
  ds_read_b128 v[28:31], v5 offset:0
  ds_read_b128 v[44:47], v5 offset:4096
  ds_read_b128 v[32:35], v6 offset:0
  ds_read_b128 v[48:51], v6 offset:4096
  ds_read_b128 v[36:39], v7 offset:0
  ds_read_b128 v[52:55], v7 offset:4096
  v_mfma_f32_16x16x32_bf16 v[96:99], v[56:59], v[8:11], 0
  v_mfma_f32_16x16x32_bf16 v[100:103], v[72:75], v[8:11], 0
  v_mfma_f32_16x16x32_bf16 v[96:99], v[60:63], v[12:15], v[96:99]
  v_mfma_f32_16x16x32_bf16 v[100:103], v[76:79], v[12:15], v[100:103]
  v_mfma_f32_16x16x32_bf16 v[96:99], v[64:67], v[16:19], v[96:99]
  v_mfma_f32_16x16x32_bf16 v[100:103], v[80:83], v[16:19], v[100:103]
  v_mfma_f32_16x16x32_bf16 v[96:99], v[68:71], v[20:23], v[96:99]
  v_mfma_f32_16x16x32_bf16 v[100:103], v[84:87], v[20:23], v[100:103]
  s_waitcnt lgkmcnt(0)
  v_mfma_f32_16x16x32_bf16 v[104:107], v[24:27], v[8:11], 0
  v_mfma_f32_16x16x32_bf16 v[108:111], v[40:43], v[8:11], 0
  v_mfma_f32_16x16x32_bf16 v[104:107], v[28:31], v[12:15], v[104:107]
  v_mfma_f32_16x16x32_bf16 v[108:111], v[44:47], v[12:15], v[108:111]
  v_mfma_f32_16x16x32_bf16 v[104:107], v[32:35], v[16:19], v[104:107]
  v_mfma_f32_16x16x32_bf16 v[108:111], v[48:51], v[16:19], v[108:111]
  v_mfma_f32_16x16x32_bf16 v[104:107], v[36:39], v[20:23], v[104:107]
  v_mfma_f32_16x16x32_bf16 v[108:111], v[52:55], v[20:23], v[108:111]
  v_cndmask_b32 v88, v88, v92, s[56:57]
  v_cndmask_b32 v89, v89, v93, s[56:57]
  v_cndmask_b32 v90, v90, v94, s[56:57]
  v_cndmask_b32 v91, v91, v95, s[56:57]
  v_cndmask_b32 v88, v88, v96, s[58:59]
  v_cndmask_b32 v89, v89, v97, s[58:59]
  v_cndmask_b32 v90, v90, v98, s[58:59]
  v_cndmask_b32 v91, v91, v99, s[58:59]
  v_cndmask_b32 v88, v88, v100, s[60:61]
  v_cndmask_b32 v89, v89, v101, s[60:61]
  v_cndmask_b32 v90, v90, v102, s[60:61]
  v_cndmask_b32 v91, v91, v103, s[60:61]
  v_cndmask_b32 v104, v104, v108, s[62:63]
  v_cndmask_b32 v105, v105, v109, s[62:63]
  v_cndmask_b32 v106, v106, v110, s[62:63]
  v_cndmask_b32 v107, v107, v111, s[62:63]
  s_branch L_a_mrg
L_a_no3a:
  v_mfma_f32_16x16x32_bf16 v[96:99], v[56:59], v[8:11], 0
  v_mfma_f32_16x16x32_bf16 v[100:103], v[72:75], v[8:11], 0
  v_mfma_f32_16x16x32_bf16 v[96:99], v[60:63], v[12:15], v[96:99]
  v_mfma_f32_16x16x32_bf16 v[100:103], v[76:79], v[12:15], v[100:103]
  v_mfma_f32_16x16x32_bf16 v[96:99], v[64:67], v[16:19], v[96:99]
  v_mfma_f32_16x16x32_bf16 v[100:103], v[80:83], v[16:19], v[100:103]
  v_mfma_f32_16x16x32_bf16 v[96:99], v[68:71], v[20:23], v[96:99]
  v_mfma_f32_16x16x32_bf16 v[100:103], v[84:87], v[20:23], v[100:103]
  v_cndmask_b32 v88, v88, v92, s[56:57]
  v_cndmask_b32 v89, v89, v93, s[56:57]
  v_cndmask_b32 v90, v90, v94, s[56:57]
  v_cndmask_b32 v91, v91, v95, s[56:57]
  s_nop 2
  v_cndmask_b32 v88, v88, v96, s[58:59]
  v_cndmask_b32 v89, v89, v97, s[58:59]
  v_cndmask_b32 v90, v90, v98, s[58:59]
  v_cndmask_b32 v91, v91, v99, s[58:59]
  v_cndmask_b32 v88, v88, v100, s[60:61]
  v_cndmask_b32 v89, v89, v101, s[60:61]
  v_cndmask_b32 v90, v90, v102, s[60:61]
  v_cndmask_b32 v91, v91, v103, s[60:61]
L_a_mrg:
  v_cvt_pk_bf16_f32 v88, 0, v88
  v_cvt_pk_bf16_f32 v89, 0, v89
  v_cvt_pk_bf16_f32 v90, 0, v90
  v_cvt_pk_bf16_f32 v91, 0, v91
  v_cvt_pk_bf16_f32 v104, 0, v104
  v_cvt_pk_bf16_f32 v105, 0, v105
  v_cvt_pk_bf16_f32 v106, 0, v106
  v_cvt_pk_bf16_f32 v107, 0, v107
  v_mul_f32 v88, s17, v88
  v_mul_f32 v89, s17, v89
  v_mul_f32 v90, s17, v90
  v_mul_f32 v91, s17, v91
  v_mul_f32 v104, s17, v104
  v_mul_f32 v105, s17, v105
  v_mul_f32 v106, s17, v106
  v_mul_f32 v107, s17, v107
  v_cvt_pk_bf16_f32 v88, 0, v88
  v_cvt_pk_bf16_f32 v89, 0, v89
  v_cvt_pk_bf16_f32 v90, 0, v90
  v_cvt_pk_bf16_f32 v91, 0, v91
  v_cvt_pk_bf16_f32 v104, 0, v104
  v_cvt_pk_bf16_f32 v105, 0, v105
  v_cvt_pk_bf16_f32 v106, 0, v106
  v_cvt_pk_bf16_f32 v107, 0, v107
  v_max3_f32 v112, v88, v89, v90
  v_max3_f32 v112, v112, v91, v104
  v_max3_f32 v112, v112, v105, v106
  v_max_f32 v112, v112, v107
  s_nop 1
  v_max_f32_dpp v112, v112, v112 quad_perm:[1,0,3,2] row_mask:0xf bank_mask:0xf
  s_nop 1
  v_max_f32_dpp v112, v112, v112 quad_perm:[2,3,0,1] row_mask:0xf bank_mask:0xf
  v_mov_b32 v113, v112
  s_nop 1
  v_permlane32_swap_b32 v112, v113
  v_max_f32 v112, v112, v113
  v_mov_b32 v113, v112
  s_nop 1
  v_permlane16_swap_b32 v112, v113
  v_max_f32 v112, v112, v113
  ds_write_b32 v123, v112 offset:64
  v_mov_b32 v125, 1
  s_mov_b64 exec, 1
  ds_add_u32 v3, v125 offset:4
  s_mov_b64 exec, -1
  s_mov_b32 s30, 0
L_a_mspin:
  s_add_u32 s30, s30, 1
  s_cmp_gt_u32 s30, 524288
  s_cbranch_scc1 L_a_mok
  ds_read_b32 v112, v3 offset:4
  ds_read_b128 v[116:119], v120 offset:64
  s_waitcnt lgkmcnt(0)
  v_readfirstlane_b32 s27, v112
  s_cmp_lt_u32 s27, 4
  s_cbranch_scc1 L_a_mspin
L_a_mok:
  v_max3_f32 v112, v116, v117, v118
  v_max_f32 v112, v112, v119
  v_sub_f32 v88, v88, v112
  v_sub_f32 v89, v89, v112
  v_sub_f32 v90, v90, v112
  v_sub_f32 v91, v91, v112
  v_sub_f32 v104, v104, v112
  v_sub_f32 v105, v105, v112
  v_sub_f32 v106, v106, v112
  v_sub_f32 v107, v107, v112
  v_mul_f32 v88, s18, v88
  v_mul_f32 v89, s18, v89
  v_mul_f32 v90, s18, v90
  v_mul_f32 v91, s18, v91
  v_mul_f32 v104, s18, v104
  v_mul_f32 v105, s18, v105
  v_mul_f32 v106, s18, v106
  v_mul_f32 v107, s18, v107
  v_exp_f32 v88, v88
  v_exp_f32 v89, v89
  v_exp_f32 v90, v90
  v_exp_f32 v91, v91
  v_exp_f32 v104, v104
  v_exp_f32 v105, v105
  v_exp_f32 v106, v106
  v_exp_f32 v107, v107
  v_cvt_pk_bf16_f32 v112, v88, v89
  v_cvt_pk_bf16_f32 v113, v90, v91
  v_cvt_pk_bf16_f32 v114, v104, v105
  v_cvt_pk_bf16_f32 v115, v106, v107
  ds_write_b64 v122, v[112:113]
  s_cmp_le_u32 s29, 7
  s_cbranch_scc1 L_a_no3b
  ds_write_b64 v124, v[114:115]
L_a_no3b:
  v_mov_b32 v125, 1
  s_mov_b64 exec, 1
  ds_add_u32 v3, v125 offset:12
  s_mov_b64 exec, -1
  v_pk_add_f32 v[88:89], v[88:89], v[90:91]
  v_pk_add_f32 v[104:105], v[104:105], v[106:107]
  v_add_f32 v88, v88, v89
  v_add_f32 v104, v104, v105
  v_fmac_f32 v88, 0.5, v104
  s_nop 1
  v_add_f32_dpp v88, v88, v88 quad_perm:[1,0,3,2] row_mask:0xf bank_mask:0xf
  s_nop 1
  v_add_f32_dpp v88, v88, v88 quad_perm:[2,3,0,1] row_mask:0xf bank_mask:0xf
  v_mov_b32 v89, v88
  s_nop 1
  v_permlane32_swap_b32 v88, v89
  v_add_f32 v88, v88, v89
  v_mov_b32 v89, v88
  s_nop 1
  v_permlane16_swap_b32 v88, v89
  v_add_f32 v88, v88, v89
  ds_write_b32 v123, v88 offset:128
  s_lshl_b32 s31, s4, 15
  s_add_u32 s31, s31, 393216
  v_mov_b32 v125, 1
  s_mov_b64 exec, 1
  ds_add_u32 v3, v125 offset:16
  s_mov_b64 exec, -1
  s_setprio 0
  s_cmp_ge_u32 s7, 4
  s_cbranch_scc1 L_a_v12
  s_mov_b64 s[12:13], s[40:41]
  s_mov_b32 s14, 0x400000
  s_mov_b32 s15, 0x20000
  v_lshrrev_b32 v9, 5, v0
  v_bfe_u32 v112, v0, 3, 2
  v_lshl_add_u32 v112, v9, 3, v112
  v_and_b32 v113, 7, v0
  v_lshlrev_b32 v113, 4, v113
  v_lshl_add_u32 v112, v112, 10, v113
  v_lshlrev_b32 v113, 5, v9
  v_xor_b32 v112, v112, v113
  v_xor_b32 v113, 64, v112
  s_lshr_b32 s25, s19, 1
  s_and_b32 s22, s19, 1
  s_lshl_b32 s27, s20, 1
  s_add_u32 s27, s27, s25
  s_lshl_b32 s61, s4, 2
  s_add_u32 s61, s61, s27
  s_lshl_b32 s61, s61, 17
  s_lshl_b32 s60, s22, 12
  s_add_u32 s61, s61, s60
  s_lshl_b32 s60, s21, 7
  s_add_u32 s61, s61, s60
  s_lshl_b32 s60, s19, 13
  s_add_u32 s60, s60, 8192
  v_bfe_u32 v8, v0, 2, 2
  v_and_b32 v10, 3, v0
  v_lshl_add_u32 v4, v2, 11, s60
  v_lshrrev_b32 v11, 1, v8
  v_mul_u32_u24 v11, 544, v11
  v_add_u32 v4, v4, v11
  v_and_b32 v11, 1, v8
  v_lshl_add_u32 v4, v11, 7, v4
  v_lshl_add_u32 v4, v10, 3, v4
  v_and_b32 v11, 1, v2
  v_lshl_add_u32 v4, v11, 6, v4
  v_xor_b32 v5, 32, v4
  v_xor_b32 v6, 64, v4
  v_xor_b32 v7, 0x60, v4
  v_mul_u32_u24 v8, 3, v8
  v_min_u32 v10, 2, v10
  v_add_u32 v8, v8, v10
  v_lshlrev_b32 v8, 6, v8
  v_lshl_add_u32 v104, v2, 4, v8
  s_mul_i32 s28, s27, 6144
  s_mul_i32 s29, s22, 1536
  s_add_u32 s28, s28, s29
  s_add_u32 s28, s28, s31
  s_lshl_b32 s29, s27, 6
  s_add_u32 s29, s29, s31
  s_add_u32 s29, s29, 24576
  v_lshlrev_b32 v105, 8, v2
  s_lshl_b32 s27, s19, 10
  v_lshl_add_u32 v110, v0, 4, s27
  s_lshl_b32 s27, s21, 14
  s_lshl_b32 s25, s4, 10
  s_add_u32 s27, s27, s25
  s_lshl_b32 s25, s20, 9
  s_add_u32 s27, s27, s25
  s_add_u32 s27, s27, 1048576
  v_and_b32 v111, 31, v0
  v_lshl_add_u32 v111, v111, 4, s27
  v_lshl_add_u32 v111, v9, 13, v111
  v_mov_b32 v107, 1
  v_mov_b32 v106, s24
  s_mov_b32 s30, 0
L_lw_17:
  s_add_u32 s30, s30, 1
  s_cmp_gt_u32 s30, 524288
  s_cbranch_scc1 L_lw_18
  ds_read_b32 v125, v3 offset:8
  s_waitcnt lgkmcnt(0)
  v_readfirstlane_b32 s27, v125
  s_cmp_ge_u32 s27, 11
  s_cbranch_scc1 L_lw_18
  s_sleep 2
  s_branch L_lw_17
L_lw_18:
  s_mov_b32 m0, s60
  s_add_u32 s60, s60, 1024
  buffer_load_dwordx4 v112, s[12:15], s61 offen  lds
  s_add_u32 s61, s61, 16384
  s_mov_b32 m0, s60
  s_add_u32 s60, s60, 1024
  buffer_load_dwordx4 v112, s[12:15], s61 offen  lds
  s_add_u32 s61, s61, 16384
  s_mov_b32 m0, s60
  s_add_u32 s60, s60, 1024
  buffer_load_dwordx4 v113, s[12:15], s61 offen  lds
  s_add_u32 s61, s61, 16384
  s_mov_b32 m0, s60
  s_add_u32 s60, s60, 1024
  buffer_load_dwordx4 v113, s[12:15], s61 offen  lds
  s_add_u32 s61, s61, 16384
  s_mov_b32 m0, s60
  s_add_u32 s60, s60, 1024
  buffer_load_dwordx4 v112, s[12:15], s61 offen  lds
  s_add_u32 s61, s61, 16384
  s_mov_b32 m0, s60
  s_add_u32 s60, s60, 1024
  buffer_load_dwordx4 v112, s[12:15], s61 offen  lds
  s_add_u32 s61, s61, 16384
  s_mov_b32 m0, s60
  s_add_u32 s60, s60, 1024
  buffer_load_dwordx4 v113, s[12:15], s61 offen  lds
  s_add_u32 s61, s61, 16384
  s_mov_b32 m0, s60
  s_add_u32 s60, s60, 1024
  buffer_load_dwordx4 v113, s[12:15], s61 offen  lds
  s_add_u32 s61, s61, 16384
  s_mov_b32 s30, 0
L_lw_19:
  s_add_u32 s30, s30, 1
  s_cmp_gt_u32 s30, 524288
  s_cbranch_scc1 L_lw_20
  ds_read_b32 v125, v3 offset:20
  s_waitcnt lgkmcnt(0)
  v_readfirstlane_b32 s26, v125
  s_cmp_ge_u32 s26, 1
  s_cbranch_scc1 L_lw_20
  s_sleep 2
  s_branch L_lw_19
L_lw_20:
  s_and_b32 s27, s26, 1
  s_lshl_b32 s27, s27, 18
  s_add_u32 s28, s28, s27
  s_add_u32 s29, s29, s27
  s_movk_i32 s27, 0xff
  s_setprio 2
  s_waitcnt vmcnt(2)
  buffer_load_dwordx4 v[24:27], v105, s[8:11], s29 offen offset:0 sc1
  buffer_load_dwordx4 v[28:31], v105, s[8:11], s29 offen offset:16 sc1
  buffer_load_dwordx4 v[32:35], v105, s[8:11], s29 offen offset:32 sc1
  buffer_load_dwordx4 v[8:11], v104, s[8:11], s28 offen offset:0 sc1
  buffer_load_dwordx4 v[12:15], v104, s[8:11], s28 offen offset:768 sc1
  buffer_load_dwordx4 v[16:19], v104, s[8:11], s28 offen offset:3072 sc1
  buffer_load_dwordx4 v[20:23], v104, s[8:11], s28 offen offset:3840 sc1
  s_waitcnt vmcnt(7)
  ds_read_b64_tr_b16 v[36:37], v4 offset:0
  ds_read_b64_tr_b16 v[38:39], v4 offset:1024
  ds_read_b64_tr_b16 v[40:41], v4 offset:256
  ds_read_b64_tr_b16 v[42:43], v4 offset:1280
  ds_read_b64_tr_b16 v[44:45], v5 offset:0
  ds_read_b64_tr_b16 v[46:47], v5 offset:1024
  ds_read_b64_tr_b16 v[48:49], v5 offset:256
  ds_read_b64_tr_b16 v[50:51], v5 offset:1280
  ds_read_b64_tr_b16 v[52:53], v6 offset:0
  ds_read_b64_tr_b16 v[54:55], v6 offset:1024
  ds_read_b64_tr_b16 v[56:57], v6 offset:256
  ds_read_b64_tr_b16 v[58:59], v6 offset:1280
  ds_read_b64_tr_b16 v[60:61], v7 offset:0
  ds_read_b64_tr_b16 v[62:63], v7 offset:1024
  ds_read_b64_tr_b16 v[64:65], v7 offset:256
  ds_read_b64_tr_b16 v[66:67], v7 offset:1280
  s_mov_b32 s30, 0
L_st_poll:
  s_add_u32 s30, s30, 1
  s_cmp_gt_u32 s30, 524288
  s_cbranch_scc1 L_st_ok
  s_waitcnt vmcnt(4)
  v_max3_u32 v109, v24, v25, v26
  v_max3_u32 v109, v109, v27, v28
  v_max3_u32 v109, v109, v29, v30
  v_max3_u32 v109, v109, v31, v32
  v_max3_u32 v109, v109, v33, v34
  v_max_u32 v109, v109, v35
  v_cmp_eq_u32 vcc, -1, v109
  s_cbranch_vccz L_st_ok
  buffer_load_dwordx4 v[24:27], v105, s[8:11], s29 offen offset:0 sc1
  buffer_load_dwordx4 v[28:31], v105, s[8:11], s29 offen offset:16 sc1
  buffer_load_dwordx4 v[32:35], v105, s[8:11], s29 offen offset:32 sc1
  buffer_load_dwordx4 v[8:11], v104, s[8:11], s28 offen offset:0 sc1
  buffer_load_dwordx4 v[12:15], v104, s[8:11], s28 offen offset:768 sc1
  buffer_load_dwordx4 v[16:19], v104, s[8:11], s28 offen offset:3072 sc1
  buffer_load_dwordx4 v[20:23], v104, s[8:11], s28 offen offset:3840 sc1
  s_branch L_st_poll
L_st_ok:
  s_mov_b32 s30, 0
  s_branch L_wo_chk
L_wo_poll:
  s_add_u32 s30, s30, 1
  s_cmp_gt_u32 s30, 524288
  s_cbranch_scc1 L_wo_go
  buffer_load_dwordx4 v[8:11], v104, s[8:11], s28 offen offset:0 sc1
  buffer_load_dwordx4 v[12:15], v104, s[8:11], s28 offen offset:768 sc1
  buffer_load_dwordx4 v[16:19], v104, s[8:11], s28 offen offset:3072 sc1
  buffer_load_dwordx4 v[20:23], v104, s[8:11], s28 offen offset:3840 sc1
L_wo_chk:
  s_waitcnt vmcnt(3)
  v_max3_u32 v108, v8, v9, v10
  v_max_u32 v108, v108, v11
  s_waitcnt vmcnt(2)
  v_max3_u32 v108, v108, v12, v13
  v_max3_u32 v108, v108, v14, v15
  s_waitcnt vmcnt(1)
  v_max3_u32 v108, v108, v16, v17
  v_max3_u32 v108, v108, v18, v19
  s_waitcnt vmcnt(0)
  v_max3_u32 v108, v108, v20, v21
  v_max3_u32 v108, v108, v22, v23
  v_cmp_eq_u32 vcc, -1, v108
  s_cbranch_vccnz L_wo_poll
L_wo_go:
  s_waitcnt lgkmcnt(0)
  v_mfma_f32_16x16x32_bf16 v[68:71], v[8:11], v[36:39], 0
  v_max3_f32 v108, v24, v26, v28
  v_max3_f32 v109, v30, v32, v34
  v_max_f32 v108, v108, v109
  v_mfma_f32_16x16x32_bf16 v[68:71], v[12:15], v[40:43], v[68:71]
  v_sub_f32 v24, v24, v108
  v_sub_f32 v26, v26, v108
  v_sub_f32 v28, v28, v108
  v_mfma_f32_16x16x32_bf16 v[72:75], v[16:19], v[36:39], 0
  v_sub_f32 v30, v30, v108
  v_sub_f32 v32, v32, v108
  v_sub_f32 v34, v34, v108
  v_mfma_f32_16x16x32_bf16 v[72:75], v[20:23], v[40:43], v[72:75]
  v_mul_f32 v24, s18, v24
  v_mul_f32 v26, s18, v26
  v_mul_f32 v28, s18, v28
  v_mfma_f32_16x16x32_bf16 v[76:79], v[8:11], v[44:47], 0
  v_mul_f32 v30, s18, v30
  v_mul_f32 v32, s18, v32
  v_mul_f32 v34, s18, v34
  v_mfma_f32_16x16x32_bf16 v[76:79], v[12:15], v[48:51], v[76:79]
  v_exp_f32 v24, v24
  v_exp_f32 v26, v26
  v_exp_f32 v28, v28
  v_mfma_f32_16x16x32_bf16 v[80:83], v[16:19], v[44:47], 0
  v_exp_f32 v30, v30
  v_exp_f32 v32, v32
  v_exp_f32 v34, v34
  v_mfma_f32_16x16x32_bf16 v[80:83], v[20:23], v[48:51], v[80:83]
  v_mul_f32 v109, v24, v25
  v_fmac_f32 v109, v26, v27
  v_fmac_f32 v109, v28, v29
  v_mfma_f32_16x16x32_bf16 v[84:87], v[8:11], v[52:55], 0
  v_fmac_f32 v109, v30, v31
  v_fmac_f32 v109, v32, v33
  v_mfma_f32_16x16x32_bf16 v[84:87], v[12:15], v[56:59], v[84:87]
  v_fmac_f32 v109, v34, v35
  v_rcp_f32 v109, v109
  v_mfma_f32_16x16x32_bf16 v[88:91], v[16:19], v[52:55], 0
  v_mul_f32 v100, v24, v68
  v_fmac_f32 v100, v26, v69
  v_mfma_f32_16x16x32_bf16 v[88:91], v[20:23], v[56:59], v[88:91]
  v_fmac_f32 v100, v28, v70
  v_fmac_f32 v100, v30, v72
  v_mfma_f32_16x16x32_bf16 v[92:95], v[8:11], v[60:63], 0
  v_fmac_f32 v100, v32, v73
  v_fmac_f32 v100, v34, v74
  v_mfma_f32_16x16x32_bf16 v[92:95], v[12:15], v[64:67], v[92:95]
  v_mul_f32 v101, v24, v76
  v_fmac_f32 v101, v26, v77
  v_mfma_f32_16x16x32_bf16 v[96:99], v[16:19], v[60:63], 0
  v_fmac_f32 v101, v28, v78
  v_fmac_f32 v101, v30, v80
  v_mfma_f32_16x16x32_bf16 v[96:99], v[20:23], v[64:67], v[96:99]
  v_fmac_f32 v101, v32, v81
  v_fmac_f32 v101, v34, v82
  v_mul_f32 v102, v24, v84
  v_fmac_f32 v102, v26, v85
  v_fmac_f32 v102, v28, v86
  v_fmac_f32 v102, v30, v88
  v_fmac_f32 v102, v32, v89
  v_fmac_f32 v102, v34, v90
  v_pk_mul_f32 v[100:101], v[100:101], v[108:109] op_sel:[0,1]
  v_mul_f32 v103, v24, v92
  v_fmac_f32 v103, v26, v93
  v_fmac_f32 v103, v28, v94
  v_fmac_f32 v103, v30, v96
  v_fmac_f32 v103, v32, v97
  v_fmac_f32 v103, v34, v98
  v_pk_mul_f32 v[102:103], v[102:103], v[108:109] op_sel:[0,1]
  s_cmp_eq_u32 s3, 1
  s_cbranch_scc1 L_c_red
  ds_write_b128 v110, v[100:103] offset:4096
  s_mov_b64 exec, 1
  ds_add_u32 v3, v107 offset:28
  s_mov_b64 exec, -1
  s_endpgm
L_c_red:
  s_mov_b32 s30, 0
L_cr_spin:
  s_add_u32 s30, s30, 1
  s_cmp_gt_u32 s30, 524288
  s_cbranch_scc1 L_cr_go
  ds_read_b32 v8, v3 offset:28
  ds_read_b128 v[12:15], v110 offset:5120
  ds_read_b128 v[16:19], v110 offset:6144
  ds_read_b128 v[20:23], v110 offset:7168
  s_waitcnt lgkmcnt(0)
  v_readfirstlane_b32 s25, v8
  s_cmp_lt_u32 s25, 3
  s_cbranch_scc1 L_cr_spin
L_cr_go:
  v_pk_add_f32 v[100:101], v[100:101], v[12:13]
  v_pk_add_f32 v[16:17], v[16:17], v[20:21]
  v_pk_add_f32 v[102:103], v[102:103], v[14:15]
  v_pk_add_f32 v[18:19], v[18:19], v[22:23]
  v_pk_add_f32 v[100:101], v[100:101], v[16:17]
  v_pk_add_f32 v[102:103], v[102:103], v[18:19]
  v_bfi_b32 v100, s27, v106, v100
  v_bfi_b32 v102, s27, v106, v102
  buffer_store_dwordx4 v[100:103], v111, s[8:11], 0 offen sc1
  s_waitcnt vmcnt(0)
  s_mov_b64 exec, 1
  ds_add_u32 v3, v107 offset:28
  s_mov_b64 exec, -1
  s_endpgm
L_a_v12:
  s_cmp_lg_u32 s3, 4
  s_cbranch_scc1 L_exit
  s_mov_b32 s3, 16
  s_mov_b32 s29, 16
  s_mov_b32 s31, 131072
  v_lshlrev_b32 v8, 4, v0
  s_waitcnt vmcnt(0)
  ds_read_b128 v[12:15], v8 offset:8192
  ds_read_b128 v[16:19], v8 offset:9216
  ds_read_b128 v[20:23], v8 offset:10240
  ds_read_b128 v[24:27], v8 offset:11264
  ds_read_b128 v[28:31], v8 offset:12288
  ds_read_b128 v[32:35], v8 offset:13312
  ds_read_b128 v[36:39], v8 offset:14336
  ds_read_b128 v[40:43], v8 offset:15360
  s_branch L_v_go
L_a_fpf:
  s_lshl_b32 s27, s6, 1
  s_add_u32 s27, s27, s7
  s_sub_u32 s27, s27, 4
  s_lshl_b32 s27, s27, 2
  s_add_u32 s27, s27, s19
  s_mov_b64 s[12:13], s[44:45]
  s_mov_b32 s14, 0x1c0000
  s_mov_b32 s15, 0x20000
  s_and_b32 s28, s27, 1
  s_cbranch_scc0 L_a_fpf2
  s_mov_b64 s[12:13], s[46:47]
L_a_fpf2:
  v_lshrrev_b32 v8, 2, v0
  v_mul_u32_u24 v8, 3584, v8
  v_and_b32 v9, 3, v0
  v_lshl_add_u32 v8, v9, 7, v8
  s_lshr_b32 s28, s27, 1
  s_lshr_b32 s29, s28, 2
  s_lshl_b32 s29, s29, 2
  s_add_u32 s28, s28, s29
  s_add_u32 s28, s28, 4
  s_mul_i32 s28, s28, 57344
  s_mul_i32 s29, s4, 448
  s_and_b32 s29, s29, -128
  s_add_u32 s28, s28, s29
  s_mov_b64 s[16:17], s[48:49]
  s_mov_b32 s18, 0x1c0000
  s_mov_b32 s19, 0x20000
  v_min_u32 v12, 27, v0
  v_lshrrev_b32 v12, 2, v12
  v_lshlrev_b32 v12, 10, v12
  v_lshl_add_u32 v12, v9, 7, v12
  s_mul_i32 s22, s4, 229376
  s_mul_i32 s29, s27, 7168
  s_add_u32 s22, s22, s29
  s_setprio 0
  buffer_load_dword v10, v8, s[12:15], s28 offen
  buffer_load_dword v11, v12, s[16:19], s22 offen
  s_endpgm
L_w0_go:
  v_lshlrev_b32 v5, 4, v0
  v_add_u32 v7, 0x1000, v5
  v_lshlrev_b32 v6, 2, v0
  s_lshl_b32 s27, s4, 14
  s_add_u32 s27, s27, 65536
  s_lshl_b32 s29, s6, 11
  v_add_u32 v8, s29, v5
  v_and_b32 v47, 31, v0
  v_lshlrev_b32 v47, 3, v47
  v_add_u32 v47, 8448, v47
  v_lshrrev_b32 v46, 5, v0
  v_mul_u32_u24 v46, 131072, v46
  v_add_u32 v46, v46, v47
  v_lshlrev_b32 v44, 1, v1
  v_lshl_add_u32 v44, v2, 7, v44
  s_lshl_b32 s31, s4, 15
  s_add_u32 s31, s31, 393216
  s_mov_b32 s23, 0xffff0000
  s_lshl_b32 s17, s6, 2
  s_add_u32 s17, s17, s7
  s_and_b32 s20, s17, 1
  s_lshr_b32 s21, s17, 1
  s_mov_b64 s[12:13], s[32:33]
  s_mov_b32 s14, 0x1000
  s_mov_b32 s15, 0x20000
  s_lshl_b32 s19, s20, 11
  s_lshl_b32 s28, s21, 7
  s_add_u32 s19, s19, s28
  v_and_b32 v104, 1, v2
  v_lshlrev_b32 v104, 10, v104
  v_lshrrev_b32 v9, 5, v0
  v_lshl_add_u32 v104, v9, 6, v104
  v_lshl_add_u32 v103, v1, 2, v104
  v_lshl_add_u32 v104, v1, 1, v104
  s_add_u32 s22, s19, s31
  s_add_u32 s22, s22, 28672
  s_getreg_b32 s25, hwreg(HW_REG_XCC_ID, 0, 4)
  s_lshl_b32 s60, s4, 14
  s_add_u32 s60, s60, 65536
  s_lshl_b32 s30, s5, 3
  s_add_u32 s60, s60, s30
  s_add_u32 s60, s60, 8448
  v_mov_b32 v106, s25
  s_waitcnt lgkmcnt(0)
  s_add_u32 s24, s24, 1
  s_and_b32 s30, s24, 0xff
  s_cselect_b32 s30, 0, 1
  s_add_u32 s24, s24, s30
  v_mov_b32 v107, s24
  s_mov_b64 exec, 1
  buffer_store_dwordx2 v[106:107], v3, s[8:11], s60 offen
  s_add_u32 s60, s60, 131072
  s_mov_b64 exec, -1
  s_mov_b64 s[56:57], s[36:37]
  s_mov_b32 s58, 0x4000000
  s_mov_b32 s59, 0x20000
  s_add_u32 s16, s61, 8192
  buffer_load_dword v109, v3, s[56:59], s16 offen nt
  s_waitcnt vmcnt(0)
L_k_ok:
  s_mov_b32 s29, s27
  s_mov_b32 s30, 0
L_q_poll:
  s_add_u32 s30, s30, 1
  s_cmp_gt_u32 s30, 524288
  s_cbranch_scc1 L_q_ok2
  buffer_load_dwordx4 v[48:51], v8, s[8:11], s29 offen sc1
  buffer_load_dwordx4 v[52:55], v8, s[8:11], s29 offen offset:1024 sc1
  buffer_load_dwordx2 v[56:57], v47, s[8:11], s27 offen sc1
  s_cmp_ge_u32 s30, 10
  s_cselect_b32 s29, 131072, 0
  s_add_u32 s29, s29, s27
  s_waitcnt vmcnt(0)
  v_xor_b32 v40, s24, v49
  v_xor_b32 v41, s24, v51
  v_xor_b32 v42, s24, v53
  v_or3_b32 v40, v40, v41, v42
  v_xor_b32 v41, s24, v55
  v_or_b32 v40, v40, v41
  v_cmp_ne_u32 vcc, 0, v40
  s_cbranch_vccnz L_q_poll
L_q_ok2:
  ds_write_b16 v44, v48 offset:2048
  ds_write_b16_d16_hi v44, v48 offset:2080
  ds_write_b16 v44, v50 offset:2112
  ds_write_b16_d16_hi v44, v50 offset:2144
  ds_write_b16 v44, v52 offset:2560
  ds_write_b16_d16_hi v44, v52 offset:2592
  ds_write_b16 v44, v54 offset:2624
  ds_write_b16_d16_hi v44, v54 offset:2656
  v_mov_b32 v45, 1
  ds_write_b32 v3, v45 offset:0
  s_mov_b32 s30, 0
  s_branch L_w_chk
L_w_p:
  s_add_u32 s30, s30, 1
  s_cmp_gt_u32 s30, 524288
  s_cbranch_scc1 L_w_ok
  s_cmp_lg_u32 s30, 10
  s_cbranch_scc1 L_w_loc
  v_mov_b32 v47, v46
  s_mov_b64 exec, 1
  buffer_store_dwordx2 v[106:107], v3, s[8:11], s60 offen sc1
  s_mov_b64 exec, -1
L_w_loc:
  buffer_load_dwordx2 v[56:57], v47, s[8:11], s27 offen sc1
  s_waitcnt vmcnt(0)
L_w_chk:
  v_cmp_eq_u32 vcc, s24, v57
  s_or_b32 s26, vcc_lo, vcc_hi
  s_cmp_lg_u32 s26, -1
  s_cbranch_scc1 L_w_p
L_w_ok:
  v_cmp_ne_u32 s[62:63], s25, v56
  s_and_b64 s[62:63], s[62:63], vcc
  s_mov_b32 s26, 2
  s_cbranch_scc0 L_w_fin
  s_mov_b32 s26, 1
  s_mov_b64 exec, 1
  buffer_store_dwordx2 v[106:107], v3, s[8:11], s60 offen sc1
  s_mov_b64 exec, -1
  s_add_u32 s62, s27, 139264
  s_mov_b32 s30, 0
L_w_gp:
  s_add_u32 s30, s30, 1
  s_cmp_gt_u32 s30, 524288
  s_cbranch_scc1 L_w_fin
  buffer_load_dwordx2 v[56:57], v3, s[8:11], s62 offen sc1
  s_waitcnt vmcnt(0)
  v_cmp_eq_u32 vcc, s24, v57
  s_cbranch_vccz L_w_gp
L_w_fin:
  s_and_b32 s16, s26, 1
  s_lshl_b32 s16, s16, 18
  s_add_u32 s31, s31, s16
  s_add_u32 s22, s22, s16
  v_mov_b32 v45, s26
  ds_write_b32 v3, v45 offset:20
  s_and_b32 s18, s24, 0xff
  s_lshl_b32 s27, s7, 3
  s_lshl_b32 s28, s6, 8
  s_add_u32 s27, s27, s28
  s_add_u32 s27, s27, s31
  s_add_u32 s27, s27, 24576
  v_lshlrev_b32 v46, 6, v2
  v_lshlrev_b32 v9, 4, v2
  s_mov_b32 s30, 0
L_lw_21:
  s_add_u32 s30, s30, 1
  s_cmp_gt_u32 s30, 524288
  s_cbranch_scc1 L_lw_22
  ds_read_b32 v45, v3 offset:16
  s_waitcnt lgkmcnt(0)
  v_readfirstlane_b32 s16, v45
  s_cmp_ge_u32 s16, 4
  s_cbranch_scc1 L_lw_22
  s_sleep 2
  s_branch L_lw_21
L_lw_22:
  ds_read_b128 v[60:63], v9 offset:64
  ds_read_b128 v[64:67], v9 offset:128
  s_waitcnt lgkmcnt(0)
  v_max3_f32 v60, v60, v61, v62
  v_max_f32 v60, v60, v63
  v_add_f32 v64, v64, v65
  v_add_f32 v66, v66, v67
  v_add_f32 v61, v64, v66
  v_min_u32 v60, -2, v60
  v_min_u32 v61, -2, v61
  s_mov_b32 exec_lo, 0x00010001
  s_mov_b32 exec_hi, 0x00010001
  s_cmp_lg_u32 s26, 2
  s_cbranch_scc1 L_ls_23
  buffer_store_dwordx2 v[60:61], v46, s[8:11], s27 offen
  s_branch L_ls_24
L_ls_23:
  buffer_store_dwordx2 v[60:61], v46, s[8:11], s27 offen sc1
L_ls_24:
  s_mov_b64 exec, -1
  v_mov_b32 v45, 1
  s_mov_b64 exec, 1
  ds_add_u32 v3, v45 offset:8
  s_mov_b64 exec, -1
  s_cmp_ge_u32 s7, 4
  s_cbranch_scc1 L_final
  buffer_load_ushort v101, v104, s[12:15], s19 offen
  buffer_load_ushort v102, v104, s[12:15], s19 offen offset:32
  s_lshl_b32 s27, s17, 13
  s_add_u32 s27, s27, 1048576
  s_waitcnt vmcnt(0)
  v_lshlrev_b32 v101, 16, v101
  v_lshlrev_b32 v102, 16, v102
  s_setprio 1
  s_mov_b32 s30, 0
L_lw_25:
  s_add_u32 s30, s30, 1
  s_cmp_gt_u32 s30, 524288
  s_cbranch_scc1 L_lw_26
  ds_read_b32 v45, v3 offset:28
  s_waitcnt lgkmcnt(0)
  v_readfirstlane_b32 s16, v45
  s_cmp_ge_u32 s16, 1
  s_cbranch_scc1 L_lw_26
  s_sleep 4
  s_branch L_lw_25
L_lw_26:
  s_mov_b32 s30, 0
L_lw_27:
  s_add_u32 s30, s30, 1
  s_cmp_gt_u32 s30, 524288
  s_cbranch_scc1 L_lw_28
  ds_read_b32 v45, v3 offset:28
  s_waitcnt lgkmcnt(0)
  v_readfirstlane_b32 s16, v45
  s_cmp_ge_u32 s16, 4
  s_cbranch_scc1 L_lw_28
  s_sleep 0
  s_branch L_lw_27
L_lw_28:
  s_setprio 3
  s_mov_b32 s30, 0
L_c_poll:
  s_add_u32 s30, s30, 1
  s_cmp_gt_u32 s30, 524288
  s_cbranch_scc1 L_c_ok
  buffer_load_dwordx4 v[16:19], v5, s[8:11], s27 offen offset:0 sc1
  buffer_load_dwordx4 v[20:23], v5, s[8:11], s27 offen offset:1024 sc1
  buffer_load_dwordx4 v[24:27], v5, s[8:11], s27 offen offset:2048 sc1
  buffer_load_dwordx4 v[28:31], v5, s[8:11], s27 offen offset:3072 sc1
  buffer_load_dwordx4 v[32:35], v7, s[8:11], s27 offen offset:0 sc1
  buffer_load_dwordx4 v[36:39], v7, s[8:11], s27 offen offset:1024 sc1
  buffer_load_dwordx4 v[40:43], v7, s[8:11], s27 offen offset:2048 sc1
  buffer_load_dwordx4 v[44:47], v7, s[8:11], s27 offen offset:3072 sc1
  s_waitcnt vmcnt(7)
  v_xor_b32 v16, s18, v16
  v_xor_b32 v18, s18, v18
  v_or_b32 v56, v16, v18
  s_waitcnt vmcnt(6)
  v_xor_b32 v20, s18, v20
  v_xor_b32 v22, s18, v22
  v_or3_b32 v56, v56, v20, v22
  v_pk_add_f32 v[48:49], v[16:17], v[20:21]
  v_pk_add_f32 v[50:51], v[18:19], v[22:23]
  s_waitcnt vmcnt(5)
  v_xor_b32 v24, s18, v24
  v_xor_b32 v26, s18, v26
  v_or3_b32 v56, v56, v24, v26
  v_pk_add_f32 v[48:49], v[48:49], v[24:25]
  v_pk_add_f32 v[50:51], v[50:51], v[26:27]
  s_waitcnt vmcnt(4)
  v_xor_b32 v28, s18, v28
  v_xor_b32 v30, s18, v30
  v_or3_b32 v56, v56, v28, v30
  v_pk_add_f32 v[48:49], v[48:49], v[28:29]
  v_pk_add_f32 v[50:51], v[50:51], v[30:31]
  s_waitcnt vmcnt(3)
  v_xor_b32 v32, s18, v32
  v_xor_b32 v34, s18, v34
  v_or3_b32 v56, v56, v32, v34
  v_pk_add_f32 v[48:49], v[48:49], v[32:33]
  v_pk_add_f32 v[50:51], v[50:51], v[34:35]
  s_waitcnt vmcnt(2)
  v_xor_b32 v36, s18, v36
  v_xor_b32 v38, s18, v38
  v_or3_b32 v56, v56, v36, v38
  v_pk_add_f32 v[48:49], v[48:49], v[36:37]
  v_pk_add_f32 v[50:51], v[50:51], v[38:39]
  s_waitcnt vmcnt(1)
  v_xor_b32 v40, s18, v40
  v_xor_b32 v42, s18, v42
  v_or3_b32 v56, v56, v40, v42
  v_pk_add_f32 v[48:49], v[48:49], v[40:41]
  v_pk_add_f32 v[50:51], v[50:51], v[42:43]
  s_waitcnt vmcnt(0)
  v_xor_b32 v44, s18, v44
  v_xor_b32 v46, s18, v46
  v_or3_b32 v56, v56, v44, v46
  v_cmp_ne_u32_sdwa vcc, v56, v3 src0_sel:BYTE_0 src1_sel:DWORD
  v_pk_add_f32 v[48:49], v[48:49], v[44:45]
  v_pk_add_f32 v[50:51], v[50:51], v[46:47]
  s_cbranch_vccnz L_c_poll
L_c_ok:
  s_nop 0
  v_permlane32_swap_b32 v48, v50
  v_permlane32_swap_b32 v49, v51
  v_pk_add_f32 v[48:49], v[48:49], v[50:51]
  v_cvt_pk_bf16_f32 v48, 0, v48
  v_cvt_pk_bf16_f32 v49, 0, v49
  v_add_f32 v48, v48, v101
  v_add_f32 v49, v49, v102
  v_cvt_pk_bf16_f32 v48, v48, v49
  v_min_u32 v48, -2, v48
  s_cmp_lg_u32 s26, 2
  s_cbranch_scc1 L_ls_29
  buffer_store_dword v48, v103, s[8:11], s22 offen
  s_branch L_ls_30
L_ls_29:
  buffer_store_dword v48, v103, s[8:11], s22 offen sc1
L_ls_30:
  s_cmp_lg_u32 s2, 0
  s_cbranch_scc1 L_exit
  s_mov_b64 exec, 1
  buffer_store_dword v107, v3, s[8:11], 0 offen sc1
  s_mov_b64 exec, -1
  s_endpgm
L_final:
  s_setprio 1
  s_mov_b32 s30, 0
L_lw_31:
  s_add_u32 s30, s30, 1
  s_cmp_gt_u32 s30, 524288
  s_cbranch_scc1 L_lw_32
  ds_read_b32 v45, v3 offset:36
  s_waitcnt lgkmcnt(0)
  v_readfirstlane_b32 s16, v45
  s_cmp_ge_u32 s16, 4
  s_cbranch_scc1 L_lw_32
  s_sleep 8
  s_branch L_lw_31
L_lw_32:
  s_mov_b64 s[12:13], s[50:51]
  s_mov_b32 s14, 0x1000
  s_mov_b32 s15, 0x20000
  s_sub_u32 s20, s7, 4
  v_and_b32 v8, 7, v0
  s_lshl_b32 s27, s20, 3
  v_add_u32 v8, s27, v8
  v_lshrrev_b32 v9, 5, v0
  v_lshlrev_b32 v9, 6, v9
  v_lshl_add_u32 v9, v8, 2, v9
  s_lshl_b32 s27, s6, 10
  s_lshl_b32 s28, s4, 7
  s_add_u32 s21, s27, s28
  s_add_u32 s27, s21, s31
  s_add_u32 s27, s27, 28672
  v_lshlrev_b32 v10, 5, v2
  v_lshl_add_u32 v10, v8, 1, v10
  v_and_b32 v11, 1, v2
  v_lshlrev_b32 v11, 4, v11
  s_lshl_b32 s28, s4, 3
  s_lshl_b32 s29, s6, 1
  s_add_u32 s28, s28, s29
  s_add_u32 s28, s28, s20
  s_mul_i32 s29, s28, 7168
  s_add_u32 s29, s29, 1310720
  s_mov_b32 s30, 0
L_fh_poll:
  s_add_u32 s30, s30, 1
  s_cmp_gt_u32 s30, 524288
  s_cbranch_scc1 L_fh_ok
  s_sleep 4
  buffer_load_dword v12, v9, s[8:11], s27 offen sc1
  s_waitcnt vmcnt(0)
  v_cmp_eq_u32 vcc, -1, v12
  s_cbranch_vccnz L_fh_poll
L_fh_ok:
  v_lshrrev_b32 v12, v11, v12
  v_lshlrev_b32 v12, 16, v12
  s_mov_b32 s30, 0
L_d_poll:
  s_add_u32 s30, s30, 1
  s_cmp_gt_u32 s30, 524288
  s_cbranch_scc1 L_d_ok
  buffer_load_dwordx4 v[16:19], v5, s[8:11], s29 offen offset:0 sc1
  buffer_load_dwordx4 v[20:23], v5, s[8:11], s29 offen offset:1024 sc1
  buffer_load_dwordx4 v[24:27], v5, s[8:11], s29 offen offset:2048 sc1
  buffer_load_dwordx4 v[28:31], v5, s[8:11], s29 offen offset:3072 sc1
  buffer_load_dwordx4 v[32:35], v7, s[8:11], s29 offen offset:0 sc1
  buffer_load_dwordx4 v[36:39], v7, s[8:11], s29 offen offset:1024 sc1
  buffer_load_dwordx4 v[40:43], v7, s[8:11], s29 offen offset:2048 sc1
  s_waitcnt vmcnt(6)
  v_xor_b32 v16, s18, v16
  v_xor_b32 v18, s18, v18
  v_or_b32 v56, v16, v18
  s_waitcnt vmcnt(5)
  v_xor_b32 v20, s18, v20
  v_xor_b32 v22, s18, v22
  v_or3_b32 v56, v56, v20, v22
  v_pk_add_f32 v[48:49], v[16:17], v[20:21]
  v_pk_add_f32 v[50:51], v[18:19], v[22:23]
  s_waitcnt vmcnt(4)
  v_xor_b32 v24, s18, v24
  v_xor_b32 v26, s18, v26
  v_or3_b32 v56, v56, v24, v26
  v_pk_add_f32 v[48:49], v[48:49], v[24:25]
  v_pk_add_f32 v[50:51], v[50:51], v[26:27]
  s_waitcnt vmcnt(3)
  v_xor_b32 v28, s18, v28
  v_xor_b32 v30, s18, v30
  v_or3_b32 v56, v56, v28, v30
  v_pk_add_f32 v[48:49], v[48:49], v[28:29]
  v_pk_add_f32 v[50:51], v[50:51], v[30:31]
  s_waitcnt vmcnt(2)
  v_xor_b32 v32, s18, v32
  v_xor_b32 v34, s18, v34
  v_or3_b32 v56, v56, v32, v34
  v_pk_add_f32 v[48:49], v[48:49], v[32:33]
  v_pk_add_f32 v[50:51], v[50:51], v[34:35]
  s_waitcnt vmcnt(1)
  v_xor_b32 v36, s18, v36
  v_xor_b32 v38, s18, v38
  v_or3_b32 v56, v56, v36, v38
  v_pk_add_f32 v[48:49], v[48:49], v[36:37]
  v_pk_add_f32 v[50:51], v[50:51], v[38:39]
  s_waitcnt vmcnt(0)
  v_xor_b32 v40, s18, v40
  v_xor_b32 v42, s18, v42
  v_or3_b32 v56, v56, v40, v42
  v_cmp_ne_u32_sdwa vcc, v56, v3 src0_sel:BYTE_0 src1_sel:DWORD
  v_pk_add_f32 v[48:49], v[48:49], v[40:41]
  v_pk_add_f32 v[50:51], v[50:51], v[42:43]
  s_cbranch_vccnz L_d_poll
L_d_ok:
  s_nop 0
  v_permlane32_swap_b32 v48, v50
  v_permlane32_swap_b32 v49, v51
  v_pk_add_f32 v[48:49], v[48:49], v[50:51]
  s_nop 1
  v_permlane16_swap_b32 v48, v49
  v_add_f32 v48, v48, v49
  s_nop 1
  v_add_f32_dpp v48, v48, v48 row_ror:8 row_mask:0xf bank_mask:0xf
  v_cvt_pk_bf16_f32 v48, 0, v48
  v_add_f32 v48, v48, v12
  v_cvt_pk_bf16_f32 v48, v48, v48
  s_mov_b32 exec_lo, 0x00ff00ff
  s_mov_b32 exec_hi, 0x00ff00ff
  buffer_store_short v48, v10, s[12:15], s21 offen
  s_mov_b64 exec, -1
  s_endpgm
L_ffn:
  s_setprio 0
  s_mul_i32 s26, s4, 7
  s_add_u32 s26, s26, s21
  s_cmp_lg_u32 s5, 31
  s_cbranch_scc1 L_ffn2
  s_cmp_gt_u32 s3, 3
  s_cbranch_scc1 L_exit
  s_and_b32 s27, s4, 1
  s_lshl_b32 s27, s27, 3
  s_sub_u32 s26, s26, s27
L_ffn2:
  v_lshrrev_b32 v4, 3, v0
  v_and_b32 v5, 7, v0
  v_and_b32 v6, 2, v4
  v_xor_b32 v5, v5, v6
  v_lshlrev_b32 v5, 4, v5
  v_lshl_add_u32 v4, v4, 10, v5
  v_xor_b32 v5, 64, v4
  s_lshl_b32 s27, s26, 15
  s_lshl_b32 s28, s3, 7
  s_add_u32 s27, s27, s28
  s_lshl_b32 s22, s3, 12
  s_add_u32 s22, s22, 106496
  v_lshrrev_b32 v6, 2, v0
  v_and_b32 v7, 9, v6
  v_bfe_u32 v12, v6, 1, 1
  v_lshl_add_u32 v7, v12, 2, v7
  v_bfe_u32 v12, v6, 2, 1
  v_lshl_add_u32 v7, v12, 1, v7
  v_mul_u32_u24 v6, 3584, v7
  v_and_b32 v7, 3, v0
  v_lshl_add_u32 v6, v7, 4, v6
  v_xor_b32 v7, 32, v6
  s_mul_i32 s28, s3, 458752
  s_lshl_b32 s29, s26, 6
  s_add_u32 s28, s28, s29
  s_lshl_b32 s23, s3, 13
  s_add_u32 s23, s23, 40960
  s_mov_b64 s[12:13], s[44:45]
  s_mov_b32 s14, 0x1c0000
  s_mov_b32 s15, 0x20000
  s_mov_b64 s[16:17], s[46:47]
  s_mov_b32 s18, 0x1c0000
  s_mov_b32 s19, 0x20000
  s_and_b32 s25, s26, 1
  s_cbranch_scc0 L_f_even
  s_mov_b64 s[12:13], s[46:47]
  s_mov_b64 s[16:17], s[44:45]
L_f_even:
  s_mov_b64 s[56:57], s[48:49]
  s_mov_b32 s58, 0x1c0000
  s_mov_b32 s59, 0x20000
  s_cmp_lg_u32 s3, 1
  s_cbranch_scc1 L_f_notlb
  buffer_load_dword v14, v3, s[12:15], s29 offen
  buffer_load_dword v15, v3, s[16:19], s29 offen
  buffer_load_dword v16, v3, s[56:59], s27 offen
L_f_notlb:
  s_mov_b32 s30, 0
L_f1_spin:
  s_add_u32 s30, s30, 1
  s_cmp_gt_u32 s30, 524288
  s_cbranch_scc1 L_f1_go
  s_sleep 4
  ds_read_b64 v[12:13], v3 offset:0
  s_waitcnt lgkmcnt(0)
  v_add_u32 v12, v12, v13
  s_nop 0
  v_readfirstlane_b32 s29, v12
  s_cmp_lt_u32 s29, 5
  s_cbranch_scc1 L_f1_spin
L_f1_go:
  s_cmp_gt_u32 s3, 3
  s_cbranch_scc1 L_f_dn
  s_mov_b32 s29, s28
  s_mov_b32 s21, s23
  s_mov_b32 m0, s21
  s_add_u32 s21, s21, 1024
  buffer_load_dwordx4 v6, s[12:15], s29 offen  lds
  s_add_u32 s29, s29, 57344
  s_mov_b32 m0, s21
  s_add_u32 s21, s21, 1024
  buffer_load_dwordx4 v7, s[12:15], s29 offen  lds
  s_add_u32 s29, s29, 57344
  s_mov_b32 m0, s21
  s_add_u32 s21, s21, 1024
  buffer_load_dwordx4 v6, s[12:15], s29 offen  lds
  s_add_u32 s29, s29, 57344
  s_mov_b32 m0, s21
  s_add_u32 s21, s21, 1024
  buffer_load_dwordx4 v7, s[12:15], s29 offen  lds
  s_add_u32 s29, s29, 57344
  s_cmp_eq_u32 s5, 31
  s_cbranch_scc1 L_exit
  s_waitcnt vmcnt(0)
  s_mov_b32 s62, s21
  s_mov_b32 s63, s29
  s_mov_b32 s29, s28
  s_add_u32 s21, s23, 32768
  s_mov_b32 m0, s21
  s_add_u32 s21, s21, 1024
  buffer_load_dwordx4 v6, s[16:19], s29 offen  lds
  s_add_u32 s29, s29, 57344
  s_mov_b32 m0, s21
  s_add_u32 s21, s21, 1024
  buffer_load_dwordx4 v7, s[16:19], s29 offen  lds
  s_add_u32 s29, s29, 57344
  s_mov_b32 m0, s21
  s_add_u32 s21, s21, 1024
  buffer_load_dwordx4 v6, s[16:19], s29 offen  lds
  s_add_u32 s29, s29, 57344
  s_mov_b32 m0, s21
  s_add_u32 s21, s21, 1024
  buffer_load_dwordx4 v7, s[16:19], s29 offen  lds
  s_add_u32 s29, s29, 57344
  s_mov_b32 s60, s21
  s_mov_b32 s61, s29
  s_mov_b32 s21, s62
  s_mov_b32 s29, s63
  s_mov_b32 m0, s21
  s_add_u32 s21, s21, 1024
  buffer_load_dwordx4 v6, s[12:15], s29 offen  lds
  s_add_u32 s29, s29, 57344
  s_mov_b32 m0, s21
  s_add_u32 s21, s21, 1024
  buffer_load_dwordx4 v7, s[12:15], s29 offen  lds
  s_add_u32 s29, s29, 57344
  s_mov_b32 m0, s21
  s_add_u32 s21, s21, 1024
  buffer_load_dwordx4 v6, s[12:15], s29 offen  lds
  s_add_u32 s29, s29, 57344
  s_mov_b32 m0, s21
  s_add_u32 s21, s21, 1024
  buffer_load_dwordx4 v7, s[12:15], s29 offen  lds
  s_add_u32 s29, s29, 57344
  s_mov_b32 s21, s60
  s_mov_b32 s29, s61
  s_mov_b32 m0, s21
  s_add_u32 s21, s21, 1024
  buffer_load_dwordx4 v6, s[16:19], s29 offen  lds
  s_add_u32 s29, s29, 57344
  s_mov_b32 m0, s21
  s_add_u32 s21, s21, 1024
  buffer_load_dwordx4 v7, s[16:19], s29 offen  lds
  s_add_u32 s29, s29, 57344
  s_mov_b32 m0, s21
  s_add_u32 s21, s21, 1024
  buffer_load_dwordx4 v6, s[16:19], s29 offen  lds
  s_add_u32 s29, s29, 57344
  s_mov_b32 m0, s21
  s_add_u32 s21, s21, 1024
  buffer_load_dwordx4 v7, s[16:19], s29 offen  lds
  s_add_u32 s29, s29, 57344
  s_branch L_f_dn2
L_f_dn:
  s_mov_b32 s21, s22
  s_mov_b32 m0, s21
  s_add_u32 s21, s21, 1024
  buffer_load_dwordx4 v4, s[56:59], s27 offen  lds
  s_add_u32 s27, s27, 8192
  s_mov_b32 m0, s21
  s_add_u32 s21, s21, 1024
  buffer_load_dwordx4 v5, s[56:59], s27 offen  lds
  s_add_u32 s27, s27, 8192
  s_mov_b32 m0, s21
  s_add_u32 s21, s21, 1024
  buffer_load_dwordx4 v4, s[56:59], s27 offen  lds
  s_add_u32 s27, s27, 8192
  s_mov_b32 m0, s21
  s_add_u32 s21, s21, 1024
  buffer_load_dwordx4 v5, s[56:59], s27 offen  lds
  s_add_u32 s27, s27, 8192
  s_sub_u32 s21, s22, 16384
  s_sub_u32 s27, s27, 33280
  s_waitcnt vmcnt(0)
  s_mov_b32 m0, s21
  s_add_u32 s21, s21, 1024
  buffer_load_dwordx4 v4, s[56:59], s27 offen  lds
  s_add_u32 s27, s27, 8192
  s_mov_b32 m0, s21
  s_add_u32 s21, s21, 1024
  buffer_load_dwordx4 v5, s[56:59], s27 offen  lds
  s_add_u32 s27, s27, 8192
  s_mov_b32 m0, s21
  s_add_u32 s21, s21, 1024
  buffer_load_dwordx4 v4, s[56:59], s27 offen  lds
  s_add_u32 s27, s27, 8192
  s_mov_b32 m0, s21
  s_add_u32 s21, s21, 1024
  buffer_load_dwordx4 v5, s[56:59], s27 offen  lds
  s_add_u32 s27, s27, 8192
L_f_dn2:
  v_bfe_u32 v8, v0, 2, 2
  v_and_b32 v9, 3, v0
  v_lshlrev_b32 v104, 10, v2
  v_lshl_add_u32 v104, v8, 7, v104
  v_lshl_add_u32 v104, v9, 3, v104
  v_lshrrev_b32 v10, 1, v8
  v_and_b32 v11, 1, v2
  v_lshl_add_u32 v12, v11, 1, v10
  v_lshl_add_u32 v104, v12, 5, v104
  s_sub_u32 s22, s22, 16384
  v_add_u32 v104, s22, v104
  v_xor_b32 v105, 32, v104
  v_xor_b32 v106, 64, v104
  v_xor_b32 v107, 0x60, v104
  v_and_b32 v13, 1, v8
  v_mul_u32_u24 v108, 1056, v13
  v_lshl_add_u32 v108, v12, 6, v108
  v_lshrrev_b32 v13, 1, v2
  v_lshl_add_u32 v108, v13, 9, v108
  v_lshl_add_u32 v108, v9, 3, v108
  v_add_u32 v108, s23, v108
  v_xor_b32 v109, 32, v108
  v_lshlrev_b32 v110, 4, v0
  v_lshlrev_b32 v111, 3, v8
  s_lshl_b32 s27, s3, 10
  s_lshl_b32 s29, s25, 3
  s_add_u32 s27, s27, s29
  s_add_u32 s27, s27, 12288
  v_lshrrev_b32 v112, 3, v1
  v_lshl_add_u32 v112, v112, 8, s27
  v_lshl_add_u32 v112, v2, 6, v112
  v_bfe_u32 v115, v0, 1, 2
  v_lshl_add_u32 v112, v115, 4, v112
  v_and_b32 v115, 1, v0
  v_lshl_add_u32 v112, v115, 2, v112
  v_xor_b32 v115, 8, v112
  v_cmp_eq_u32 s[32:33], 0, v9
  v_cmp_eq_u32 s[34:35], 1, v9
  v_cmp_eq_u32 s[36:37], 2, v9
  v_cmp_eq_u32 s[38:39], 3, v9
  v_lshrrev_b32 v113, 3, v0
  v_mul_u32_u24 v113, 7168, v113
  v_and_b32 v13, 7, v0
  v_lshl_add_u32 v113, v13, 4, v113
  s_mul_i32 s28, s3, 57344
  s_lshl_b32 s29, s26, 7
  s_add_u32 s28, s28, s29
  s_add_u32 s28, s28, 1310720
  s_lshl_b32 s31, s4, 15
  s_add_u32 s31, s31, 421888
  s_mov_b32 s30, 0
L_lw_33:
  s_add_u32 s30, s30, 1
  s_cmp_gt_u32 s30, 524288
  s_cbranch_scc1 L_lw_34
  ds_read_b32 v13, v3 offset:20
  s_waitcnt lgkmcnt(0)
  v_readfirstlane_b32 s26, v13
  s_cmp_ge_u32 s26, 1
  s_cbranch_scc1 L_lw_34
  s_sleep 4
  s_branch L_lw_33
L_lw_34:
  s_and_b32 s29, s26, 1
  s_lshl_b32 s29, s29, 18
  s_add_u32 s31, s31, s29
  s_mov_b32 s23, 0xffff0000
  s_mov_b32 s21, 0xbfb8aa3b
  s_cmp_gt_u32 s3, 3
  s_cbranch_scc1 L_f_stat
  v_lshlrev_b32 v114, 10, v8
  v_lshl_add_u32 v114, v2, 4, v114
  s_lshl_b32 s27, s3, 8
  s_add_u32 s27, s27, s31
  v_mov_b32 v8, 0x3f803f80
  v_mov_b32 v9, 0x3f803f80
  v_mov_b32 v10, 0x3f803f80
  v_mov_b32 v11, 0x3f803f80
  s_waitcnt vmcnt(4)
  ds_read_b64_tr_b16 v[24:25], v108 offset:0
  ds_read_b64_tr_b16 v[26:27], v108 offset:256
  ds_read_b64_tr_b16 v[28:29], v109 offset:0
  ds_read_b64_tr_b16 v[30:31], v109 offset:256
  ds_read_b64_tr_b16 v[32:33], v108 offset:2048
  ds_read_b64_tr_b16 v[34:35], v108 offset:2304
  ds_read_b64_tr_b16 v[36:37], v109 offset:2048
  ds_read_b64_tr_b16 v[38:39], v109 offset:2304
  ds_read_b64_tr_b16 v[40:41], v108 offset:4096
  ds_read_b64_tr_b16 v[42:43], v108 offset:4352
  ds_read_b64_tr_b16 v[44:45], v109 offset:4096
  ds_read_b64_tr_b16 v[46:47], v109 offset:4352
  ds_read_b64_tr_b16 v[48:49], v108 offset:6144
  ds_read_b64_tr_b16 v[50:51], v108 offset:6400
  ds_read_b64_tr_b16 v[52:53], v109 offset:6144
  ds_read_b64_tr_b16 v[54:55], v109 offset:6400
  s_waitcnt lgkmcnt(0)
  v_mfma_f32_16x16x32_bf16 v[4:7], v[8:11], v[24:27], 0
  v_mfma_f32_16x16x32_bf16 v[116:119], v[8:11], v[28:31], 0
  v_mfma_f32_16x16x32_bf16 v[4:7], v[8:11], v[32:35], v[4:7]
  v_mfma_f32_16x16x32_bf16 v[116:119], v[8:11], v[36:39], v[116:119]
  v_mfma_f32_16x16x32_bf16 v[4:7], v[8:11], v[40:43], v[4:7]
  v_mfma_f32_16x16x32_bf16 v[116:119], v[8:11], v[44:47], v[116:119]
  v_mfma_f32_16x16x32_bf16 v[4:7], v[8:11], v[48:51], v[4:7]
  v_mfma_f32_16x16x32_bf16 v[116:119], v[8:11], v[52:55], v[116:119]
  s_waitcnt vmcnt(0)
  ds_read_b64_tr_b16 v[56:57], v108 offset:32768
  ds_read_b64_tr_b16 v[58:59], v108 offset:33024
  ds_read_b64_tr_b16 v[60:61], v109 offset:32768
  ds_read_b64_tr_b16 v[62:63], v109 offset:33024
  ds_read_b64_tr_b16 v[64:65], v108 offset:34816
  ds_read_b64_tr_b16 v[66:67], v108 offset:35072
  ds_read_b64_tr_b16 v[68:69], v109 offset:34816
  ds_read_b64_tr_b16 v[70:71], v109 offset:35072
  ds_read_b64_tr_b16 v[72:73], v108 offset:36864
  ds_read_b64_tr_b16 v[74:75], v108 offset:37120
  ds_read_b64_tr_b16 v[76:77], v109 offset:36864
  ds_read_b64_tr_b16 v[78:79], v109 offset:37120
  ds_read_b64_tr_b16 v[80:81], v108 offset:38912
  ds_read_b64_tr_b16 v[82:83], v108 offset:39168
  ds_read_b64_tr_b16 v[84:85], v109 offset:38912
  ds_read_b64_tr_b16 v[86:87], v109 offset:39168
  s_waitcnt lgkmcnt(0)
  v_mfma_f32_16x16x32_bf16 v[120:123], v[8:11], v[56:59], 0
  v_mfma_f32_16x16x32_bf16 v[124:127], v[8:11], v[60:63], 0
  v_mfma_f32_16x16x32_bf16 v[120:123], v[8:11], v[64:67], v[120:123]
  v_mfma_f32_16x16x32_bf16 v[124:127], v[8:11], v[68:71], v[124:127]
  v_mfma_f32_16x16x32_bf16 v[120:123], v[8:11], v[72:75], v[120:123]
  v_mfma_f32_16x16x32_bf16 v[124:127], v[8:11], v[76:79], v[124:127]
  v_mfma_f32_16x16x32_bf16 v[120:123], v[8:11], v[80:83], v[120:123]
  v_mfma_f32_16x16x32_bf16 v[124:127], v[8:11], v[84:87], v[124:127]
  ds_write_b32 v112, v4 offset:4096
  ds_write_b32 v112, v116 offset:4608
  s_nop 4
  ds_write_b32 v115, v120 offset:4096
  ds_write_b32 v115, v124 offset:4608
  s_waitcnt lgkmcnt(0)
  s_barrier
  s_setprio 3
  s_mov_b32 s30, 0
L_g_poll:
  s_add_u32 s30, s30, 1
  s_cmp_gt_u32 s30, 524288
  s_cbranch_scc1 L_g_ok
  buffer_load_dwordx4 v[8:11], v114, s[8:11], s27 offen offset:0 sc1
  buffer_load_dwordx4 v[12:15], v114, s[8:11], s27 offen offset:64 sc1
  buffer_load_dwordx4 v[16:19], v114, s[8:11], s27 offen offset:128 sc1
  buffer_load_dwordx4 v[20:23], v114, s[8:11], s27 offen offset:192 sc1
  s_waitcnt vmcnt(3)
  v_max3_u32 v108, v8, v9, v10
  v_max_u32 v108, v108, v11
  s_waitcnt vmcnt(2)
  v_max3_u32 v108, v108, v12, v13
  v_max3_u32 v108, v108, v14, v15
  s_waitcnt vmcnt(1)
  v_max3_u32 v108, v108, v16, v17
  v_max3_u32 v108, v108, v18, v19
  s_waitcnt vmcnt(0)
  v_max3_u32 v108, v108, v20, v21
  v_max3_u32 v108, v108, v22, v23
  v_cmp_eq_u32 vcc, -1, v108
  s_cbranch_vccnz L_g_poll
L_g_ok:
  v_mfma_f32_16x16x32_bf16 v[4:7], v[8:11], v[24:27], 0
  v_mfma_f32_16x16x32_bf16 v[4:7], v[12:15], v[32:35], v[4:7]
  v_mfma_f32_16x16x32_bf16 v[4:7], v[16:19], v[40:43], v[4:7]
  v_mfma_f32_16x16x32_bf16 v[4:7], v[20:23], v[48:51], v[4:7]
  v_mfma_f32_16x16x32_bf16 v[116:119], v[8:11], v[28:31], 0
  v_mfma_f32_16x16x32_bf16 v[116:119], v[12:15], v[36:39], v[116:119]
  v_mfma_f32_16x16x32_bf16 v[116:119], v[16:19], v[44:47], v[116:119]
  v_mfma_f32_16x16x32_bf16 v[116:119], v[20:23], v[52:55], v[116:119]
  v_mfma_f32_16x16x32_bf16 v[120:123], v[8:11], v[56:59], 0
  v_mfma_f32_16x16x32_bf16 v[120:123], v[12:15], v[64:67], v[120:123]
  v_mfma_f32_16x16x32_bf16 v[120:123], v[16:19], v[72:75], v[120:123]
  v_mfma_f32_16x16x32_bf16 v[120:123], v[20:23], v[80:83], v[120:123]
  v_mfma_f32_16x16x32_bf16 v[124:127], v[8:11], v[60:63], 0
  v_mfma_f32_16x16x32_bf16 v[124:127], v[12:15], v[68:71], v[124:127]
  v_mfma_f32_16x16x32_bf16 v[124:127], v[16:19], v[76:79], v[124:127]
  v_mfma_f32_16x16x32_bf16 v[124:127], v[20:23], v[84:87], v[124:127]
  ds_write_b32 v112, v4 offset:0
  ds_write_b32 v112, v116 offset:512
  s_nop 1
  ds_write_b32 v115, v120 offset:0
  s_nop 2
  ds_write_b32 v115, v124 offset:512
  s_waitcnt lgkmcnt(0)
  s_barrier
  s_endpgm
L_f_stat:
  v_lshlrev_b32 v114, 4, v0
  s_sub_u32 s29, s3, 4
  s_lshl_b32 s27, s29, 10
  s_add_u32 s27, s27, s31
  s_lshl_b32 s29, s29, 3
  v_mov_b32 v115, s29
  s_sub_u32 s29, s28, 229376
  s_waitcnt vmcnt(0)
  ds_read_b64_tr_b16 v[72:73], v104 offset:0
  ds_read_b64_tr_b16 v[74:75], v104 offset:512
  ds_read_b64_tr_b16 v[76:77], v105 offset:0
  ds_read_b64_tr_b16 v[78:79], v105 offset:512
  ds_read_b64_tr_b16 v[80:81], v106 offset:0
  ds_read_b64_tr_b16 v[82:83], v106 offset:512
  ds_read_b64_tr_b16 v[84:85], v107 offset:0
  ds_read_b64_tr_b16 v[86:87], v107 offset:512
  ds_read_b64_tr_b16 v[88:89], v104 offset:16384
  ds_read_b64_tr_b16 v[90:91], v104 offset:16896
  ds_read_b64_tr_b16 v[92:93], v105 offset:16384
  ds_read_b64_tr_b16 v[94:95], v105 offset:16896
  ds_read_b64_tr_b16 v[96:97], v106 offset:16384
  ds_read_b64_tr_b16 v[98:99], v106 offset:16896
  ds_read_b64_tr_b16 v[100:101], v107 offset:16384
  ds_read_b64_tr_b16 v[102:103], v107 offset:16896
  ds_read_b32 v109, v3 offset:24
  s_movk_i32 s20, 0xff
  s_waitcnt lgkmcnt(0)
  s_barrier
  ds_read_b128 v[8:11], v110 offset:16384
  ds_read_b128 v[12:15], v110 offset:17408
  ds_read_b128 v[16:19], v110 offset:18432
  ds_read_b128 v[20:23], v110 offset:19456
  s_waitcnt lgkmcnt(0)
  v_pk_add_f32 v[8:9], v[8:9], v[16:17]
  v_pk_add_f32 v[10:11], v[10:11], v[18:19]
  v_pk_add_f32 v[12:13], v[12:13], v[20:21]
  v_pk_add_f32 v[14:15], v[14:15], v[22:23]
  v_pk_add_f32 v[104:105], v[8:9], v[12:13]
  v_pk_add_f32 v[106:107], v[10:11], v[14:15]
  s_setprio 2
  s_mov_b32 s30, 0
L_s_poll:
  s_add_u32 s30, s30, 1
  s_cmp_gt_u32 s30, 524288
  s_cbranch_scc1 L_s_ok
  buffer_load_dwordx4 v[8:11], v114, s[8:11], s27 offen sc1
  s_waitcnt vmcnt(0)
  v_max3_u32 v12, v8, v9, v10
  v_max_u32 v12, v12, v11
  v_cmp_eq_u32 vcc, -1, v12
  s_cbranch_vccnz L_s_poll
L_s_ok:
  v_lshlrev_b32 v12, 16, v8
  v_and_b32 v13, s23, v8
  v_lshlrev_b32 v14, 16, v9
  v_and_b32 v15, s23, v9
  v_lshlrev_b32 v16, 16, v10
  v_and_b32 v17, s23, v10
  v_lshlrev_b32 v18, 16, v11
  v_and_b32 v19, s23, v11
  v_pk_add_f32 v[20:21], v[12:13], v[14:15]
  v_pk_mul_f32 v[24:25], v[12:13], v[12:13]
  v_pk_add_f32 v[22:23], v[16:17], v[18:19]
  v_pk_fma_f32 v[24:25], v[14:15], v[14:15], v[24:25]
  v_pk_add_f32 v[20:21], v[20:21], v[22:23]
  v_pk_fma_f32 v[24:25], v[16:17], v[16:17], v[24:25]
  v_add_f32 v20, v20, v21
  v_pk_fma_f32 v[24:25], v[18:19], v[18:19], v[24:25]
  v_add_f32 v21, v24, v25
  s_nop 1
  v_permlane32_swap_b32 v20, v21
  v_add_f32 v20, v20, v21
  v_mov_b32 v21, v20
  s_nop 1
  v_permlane16_swap_b32 v20, v21
  v_add_f32 v20, v20, v21
  s_nop 1
  v_add_f32_dpp v20, v20, v20 row_ror:8 row_mask:0xf bank_mask:0xf
  s_nop 1
  v_add_f32_dpp v20, v20, v20 row_ror:4 row_mask:0xf bank_mask:0xf
  s_nop 1
  v_add_f32_dpp v20, v20, v20 row_ror:2 row_mask:0xf bank_mask:0xf
  s_nop 1
  v_add_f32_dpp v20, v20, v20 row_ror:1 row_mask:0xf bank_mask:0xf
  v_mul_f32 v20, 0x3b000000, v20
  v_mov_b32 v21, v20
  s_nop 1
  v_permlane32_swap_b32 v20, v21
  v_fma_f32 v21, -v20, v20, v21
  v_max_f32 v21, 0, v21
  v_add_f32 v21, 0x3727c5ac, v21
  v_rsq_f32 v21, v21
  v_mul_f32 v20, -1.0, v20
  v_mul_f32 v20, v20, v21
  ds_write_b64 v115, v[20:21] offset:64
L_f_join:
  s_waitcnt lgkmcnt(0)
  s_barrier
  ds_read_b64 v[24:25], v111 offset:64
  ds_read_b128 v[8:11], v110 offset:12288
  ds_read_b128 v[12:15], v110 offset:13312
  ds_read_b128 v[16:19], v110 offset:14336
  ds_read_b128 v[20:23], v110 offset:15360
  s_waitcnt lgkmcnt(4)
  v_pk_mul_f32 v[104:105], v[104:105], v[24:25] op_sel_hi:[1,0]
  v_pk_mul_f32 v[106:107], v[106:107], v[24:25] op_sel_hi:[1,0]
  s_waitcnt lgkmcnt(0)
  v_pk_add_f32 v[8:9], v[8:9], v[16:17]
  v_pk_add_f32 v[12:13], v[12:13], v[20:21]
  v_pk_add_f32 v[10:11], v[10:11], v[18:19]
  v_pk_add_f32 v[8:9], v[8:9], v[12:13]
  v_pk_add_f32 v[14:15], v[14:15], v[22:23]
  v_pk_fma_f32 v[8:9], v[8:9], v[24:25], v[104:105] op_sel:[0,1,0]
  v_pk_add_f32 v[10:11], v[10:11], v[14:15]
  v_cvt_pk_bf16_f32 v8, 0, v8
  v_cvt_pk_bf16_f32 v9, 0, v9
  v_mul_f32 v8, s21, v8
  v_mul_f32 v9, s21, v9
  v_exp_f32 v8, v8
  v_exp_f32 v9, v9
  v_pk_fma_f32 v[10:11], v[10:11], v[24:25], v[106:107] op_sel:[0,1,0]
  v_add_f32 v8, 1.0, v8
  v_add_f32 v9, 1.0, v9
  v_rcp_f32 v8, v8
  v_rcp_f32 v9, v9
  v_cvt_pk_bf16_f32 v10, 0, v10
  v_cvt_pk_bf16_f32 v11, 0, v11
  v_cvt_pk_bf16_f32 v8, 0, v8
  v_cvt_pk_bf16_f32 v9, 0, v9
  v_pk_mul_f32 v[8:9], v[8:9], v[10:11]
  v_cvt_pk_bf16_f32 v12, v8, v9
  v_cndmask_b32 v16, 0, v12, s[32:33]
  v_cndmask_b32 v17, 0, v12, s[34:35]
  v_cndmask_b32 v18, 0, v12, s[36:37]
  v_cndmask_b32 v19, 0, v12, s[38:39]
  s_nop 1
  v_mfma_f32_16x16x32_bf16 v[24:27], v[16:19], v[72:75], 0
  v_mfma_f32_16x16x32_bf16 v[28:31], v[16:19], v[76:79], 0
  v_mfma_f32_16x16x32_bf16 v[32:35], v[16:19], v[80:83], 0
  v_mfma_f32_16x16x32_bf16 v[36:39], v[16:19], v[84:87], 0
  v_mfma_f32_16x16x32_bf16 v[40:43], v[16:19], v[88:91], 0
  v_mfma_f32_16x16x32_bf16 v[44:47], v[16:19], v[92:95], 0
  v_mfma_f32_16x16x32_bf16 v[48:51], v[16:19], v[96:99], 0
  v_mfma_f32_16x16x32_bf16 v[52:55], v[16:19], v[100:103], 0
  s_nop 0
  v_pk_add_f32 v[24:25], v[24:25], v[26:27]
  v_add_f32 v56, v24, v25
  v_bfi_b32 v56, s20, v109, v56
  v_pk_add_f32 v[28:29], v[28:29], v[30:31]
  v_add_f32 v57, v28, v29
  v_pk_add_f32 v[32:33], v[32:33], v[34:35]
  v_add_f32 v58, v32, v33
  v_bfi_b32 v58, s20, v109, v58
  v_pk_add_f32 v[36:37], v[36:37], v[38:39]
  v_add_f32 v59, v36, v37
  buffer_store_dwordx4 v[56:59], v113, s[8:11], s29 offen sc1
  v_pk_add_f32 v[40:41], v[40:41], v[42:43]
  v_add_f32 v60, v40, v41
  v_bfi_b32 v60, s20, v109, v60
  v_pk_add_f32 v[44:45], v[44:45], v[46:47]
  v_add_f32 v61, v44, v45
  v_pk_add_f32 v[48:49], v[48:49], v[50:51]
  v_add_f32 v62, v48, v49
  v_bfi_b32 v62, s20, v109, v62
  v_pk_add_f32 v[52:53], v[52:53], v[54:55]
  v_add_f32 v63, v52, v53
  buffer_store_dwordx4 v[60:63], v113, s[8:11], s28 offen sc1
L_exit:
  s_endpgm
L_code_end:
.section .rodata,"a"
.p2align 6
.amdhsa_kernel sequential_preLN__sliding_block_cached__glu_gated_glu__decode_kernel
  .amdhsa_next_free_vgpr 128
  .amdhsa_next_free_sgpr 96
  .amdhsa_accum_offset 128
  .amdhsa_group_segment_fixed_size 0
  .amdhsa_kernarg_size 96
  .amdhsa_user_sgpr_count 2
  .amdhsa_user_sgpr_kernarg_segment_ptr 1
  .amdhsa_system_sgpr_workgroup_id_x 1
  .amdhsa_float_denorm_mode_32 3
.end_amdhsa_kernel
```
